```python
import torch

def _softmax(x, axis=-1):
    return torch.softmax(x, dim=axis)
def _gelu(x):
    return torch.nn.functional.gelu(x, approximate="tanh")
def _silu(x):
    return torch.nn.functional.silu(x)
def _sigmoid(x):
    return torch.sigmoid(x)
def _layernorm(x, axis=-1, eps=1e-5):
    m = x.mean(dim=axis, keepdim=True)
    v = x.var(dim=axis, keepdim=True, unbiased=False)
    return (x - m) / torch.sqrt(v + eps)
def _scatter_add(tgt, idx, src, axis=0):
    return tgt.clone().index_add_(axis, idx, src)
def _segment_sum(src, seg, n):
    out = torch.zeros((n,) + src.shape[1:], dtype=src.dtype)
    return out.index_add_(0, seg, src)
def _pad(x, pw):
    flat = tuple(v for pair in reversed(pw) for v in pair)
    return torch.nn.functional.pad(x, flat)

kernel_name = 'gated_mix__gqa_block_cached__dense_activation_relu__decode'

def setup_inputs():

    _w = (lambda a: (lambda t: t.to(torch.bfloat16) if t.is_floating_point() else t)(torch.as_tensor(a)))
    def _A_setup():
        B, Sq, D = 4, 1, 448
        Hq, Hkv, Sk, Dh = 16, 8, 8192, 256
        assert Hq % Hkv == 0, (Hq, Hkv)
        return {
            "x": _w((lambda *s: torch.randn(*s, dtype=torch.bfloat16) * 0.05)(B, Sq, D)),
            "k_cache": _w((lambda *s: torch.randn(*s, dtype=torch.bfloat16) * 6.4)(B, Hkv, Sk, Dh)),
            "v_cache": _w((lambda *s: torch.randn(*s, dtype=torch.bfloat16) * 1.6)(B, Hkv, Sk, Dh)),
            "wq": _w((lambda *s: torch.randn(*s, dtype=torch.bfloat16) * 6.4)(D, Hq * Dh) * (D ** -0.5)),
            "wo": _w((lambda *s: torch.randn(*s, dtype=torch.bfloat16) * 1.6)(Hq * Dh, D) * ((Hq * Dh) ** -0.5)),
        }
    _A_in = _A_setup()

    def _B_setup():
        B, S, D, Dff = 4, 1, 448, 1792
        return {
            "x": _w((lambda *s: torch.randn(*s, dtype=torch.bfloat16) * 0.05)(B, S, D)),
            "w1": _w((lambda *s: torch.randn(*s, dtype=torch.bfloat16) * 0.05)(D, Dff)),
            "w2": _w((lambda *s: torch.randn(*s, dtype=torch.bfloat16) * 0.05)(Dff, D)),
        }
    _B_in = _B_setup()

    return {
        "A_x": _A_in["x"],
        "A_k_cache": _A_in["k_cache"],
        "A_v_cache": _A_in["v_cache"],
        "A_wq": _A_in["wq"],
        "A_wo": _A_in["wo"],
        "B_x": _B_in["x"],
        "B_w1": _B_in["w1"],
        "B_w2": _B_in["w2"],
        "gate_w": _w((lambda *s: torch.randn(*s, dtype=torch.bfloat16) * 0.05)(448) * 16.0),
    }

def reference(A_x, A_k_cache, A_v_cache, A_wq, A_wo, B_x, B_w1, B_w2, gate_w):
    def _A_ref(x, k_cache, v_cache, wq, wo):
        B, Sq, D = x.shape
        Hq, Dh = 16, 256
        Hkv = k_cache.shape[1]
        rep = Hq // Hkv
        q = (lambda x, *d: x.permute(*d))((x @ wq).reshape(B, Sq, Hq, Dh), 0, 2, 1, 3)
        k = (lambda x, n, axis: torch.repeat_interleave(x, n, dim=axis))(k_cache, rep, axis=1)
        v = (lambda x, n, axis: torch.repeat_interleave(x, n, dim=axis))(v_cache, rep, axis=1)
        scores = torch.einsum("bhqd,bhkd->bhqk", q, k) * (Dh ** -0.5)
        p = _softmax(scores, axis=-1)
        o = torch.einsum("bhqk,bhkd->bhqd", p, v)
        return (lambda x, *d: x.permute(*d))(o, 0, 2, 1, 3).reshape(B, Sq, Hq * Dh) @ wo

    def _B_ref(x, w1, w2):
        h = torch.einsum("bsd,df->bsf", x, w1)
        zero = torch.zeros_like(h)
        h = torch.maximum(h, zero)
        return torch.einsum("bsf,fd->bsd", h, w2)

    x = A_x
    g = _sigmoid((x * gate_w).sum(-1, keepdims=True))
    a = _A_ref(x, A_k_cache, A_v_cache, A_wq, A_wo)
    b = _B_ref(x, B_w1, B_w2)
    return g * a + (1 - g) * b
```

```asm
; @launch grid=(256,1,1) block=(512,1,1) lds=154112
.amdgcn_target "amdgcn-amd-amdhsa--gfx950"
.text
.globl gated_mix__gqa_block_cached__dense_activation_relu__decode_kernel
.p2align 8
.type gated_mix__gqa_block_cached__dense_activation_relu__decode_kernel,@function
gated_mix__gqa_block_cached__dense_activation_relu__decode_kernel:
    s_cmp_ge_u32 s2, 256
    s_cbranch_scc1 L_exit
    s_load_dwordx16 s[4:19], s[0:1], 0
    s_load_dwordx8 s[20:27], s[0:1], 64
    v_lshrrev_b32 v1, 6, v0
    v_and_b32 v0, 63, v0
    v_readfirstlane_b32 s52, v1
    s_and_b32 s53, s2, 7
    s_lshr_b32 s54, s2, 6
    s_bfe_u32 s55, s2, 0x30003
    s_lshr_b32 s56, s2, 3
    s_lshl_b32 s57, s54, 3
    s_add_u32 s57, s57, s53
    s_lshl_b32 s58, s53, 3
    s_add_u32 s58, s58, s55
    v_and_b32 v10, 15, v0
    v_lshrrev_b32 v11, 4, v0
    v_lshrrev_b32 v12, 2, v10
    v_and_b32 v13, 3, v10
    v_lshlrev_b32 v1, 9, v12
    v_lshl_add_u32 v1, v11, 6, v1
    v_lshl_add_u32 v1, v13, 4, v1
    v_add_u32 v2, 0x1000, v1
    v_lshlrev_b32 v3, 4, v0
    v_add_u32 v4, 0x1000, v3
    s_lshl_b32 s59, s57, 22
    s_lshl_b32 s60, s55, 19
    s_add_u32 s59, s59, s60
    s_mul_i32 s60, s52, 8192
    s_add_u32 s59, s59, s60
    s_mov_b32 s62, 0x22222222
    s_mov_b32 s63, 0x22222222
    s_mov_b32 s64, 0x44444444
    s_mov_b32 s65, 0x44444444
    s_mov_b32 s66, 0x88888888
    s_mov_b32 s67, 0x88888888
    s_mov_b32 s68, 0x05040100
    s_mov_b32 s69, 0x07060302
    s_mov_b32 s30, 0x8000000
    s_mov_b32 s31, 0x20000
    s_mov_b32 s34, 0x8000000
    s_mov_b32 s35, 0x20000
    s_mov_b32 s38, 4194304
    s_mov_b32 s39, 0x20000
    s_mov_b32 s43, 0x20000
    s_mov_b32 s47, 0x20000
    s_mov_b32 s51, 0x20000
    s_cmp_gt_u32 s53, 5
    s_cselect_b32 s91, 8, 0
    s_sub_u32 s91, s58, s91
    s_cmp_eq_u32 s53, 5
    s_cselect_b32 s91, 56, s91
    s_min_u32 s72, s91, 55
    s_cmp_lt_u32 s91, 56
    s_cselect_b64 s[92:93], -1, 0
    v_mov_b32 v14, 153088
    v_mov_b32 v15, 0
    ds_write_b32 v14, v15
    ds_write_b32 v14, v15 offset:4
    s_waitcnt lgkmcnt(0)
    s_mov_b32 s28, s6
    s_mov_b32 s29, s7
    s_mov_b32 s32, s8
    s_mov_b32 s33, s9
    s_mov_b32 s36, s26
    s_mov_b32 s37, s27
    s_mov_b32 s44, s4
    s_mov_b32 s45, s5
    s_mov_b32 s46, 3584
    s_mov_b32 s40, s10
    s_mov_b32 s41, s11
    s_mov_b32 s42, 3670016
    s_mov_b32 s48, s20
    s_mov_b32 s49, s21
    s_mov_b32 s50, 896
    s_mul_i32 s73, s52, 768
    s_add_u32 s73, s73, 145408
    v_and_b32 v5, 1, v11
    v_lshlrev_b32 v5, 8, v5
    v_and_b32 v14, 1, v12
    v_lshl_add_u32 v5, v14, 4, v5
    v_lshl_add_u32 v5, v13, 2, v5
    v_lshrrev_b32 v14, 1, v12
    v_lshl_add_u32 v5, v14, 1, v5
    v_add_u32 v5, s73, v5
    v_lshrrev_b32 v6, 3, v10
    v_lshlrev_b32 v6, 8, v6
    v_xor_b32 v14, v12, v11
    v_and_b32 v14, 1, v14
    v_cmp_eq_u32 vcc, 1, v14
    v_mov_b32 v15, 0x200
    s_nop 0
    v_cndmask_b32 v6, v6, v15, vcc
    v_lshrrev_b32 v14, 1, v11
    v_lshl_add_u32 v6, v14, 4, v6
    v_add_u32 v6, s73, v6
    v_lshl_add_u32 v14, v0, 2, s73
    v_mov_b32 v15, 0
    ds_write_b32 v14, v15 offset:512
    s_cmp_eq_u32 s52, 0
    s_cbranch_scc1 L_w0
    s_cmp_lg_u32 s52, 1
    s_cbranch_scc1 L_pro
    s_mov_b32 s40, s16
    s_mov_b32 s41, s17
    s_mov_b32 s42, 1605632
    v_lshrrev_b32 v14, 2, v0
    v_mul_u32_u24 v14, 3584, v14
    v_and_b32 v15, 3, v0
    v_lshl_add_u32 v14, v15, 4, v14
    s_lshl_b32 s73, s72, 6
    s_mul_i32 s75, s54, 896
    buffer_load_dwordx4 v[56:59], v3, s[44:47], s75 offen
    buffer_load_dwordx4 v[60:63], v3, s[48:51], 0 offen
    s_mov_b32 m0, 153152
    s_mov_b32 exec_hi, 0x00ffffff
    buffer_load_dwordx4 v3, s[44:47], s75 offen  lds
    s_mov_b32 exec_hi, -1
    s_mov_b64 exec, s[92:93]
    s_mov_b32 m0, 100352
    s_add_u32 s74, s73, 0
    buffer_load_dwordx4 v14, s[40:43], s74 offen  lds
    s_mov_b32 m0, 101376
    s_add_u32 s74, s73, 57344
    buffer_load_dwordx4 v14, s[40:43], s74 offen  lds
    s_mov_b32 m0, 102400
    s_add_u32 s74, s73, 114688
    buffer_load_dwordx4 v14, s[40:43], s74 offen  lds
    s_mov_b32 m0, 103424
    s_add_u32 s74, s73, 172032
    buffer_load_dwordx4 v14, s[40:43], s74 offen  lds
    s_mov_b32 m0, 104448
    s_add_u32 s74, s73, 229376
    buffer_load_dwordx4 v14, s[40:43], s74 offen  lds
    s_mov_b32 m0, 105472
    s_add_u32 s74, s73, 286720
    buffer_load_dwordx4 v14, s[40:43], s74 offen  lds
    s_mov_b32 m0, 106496
    s_add_u32 s74, s73, 344064
    buffer_load_dwordx4 v14, s[40:43], s74 offen  lds
    s_mov_b32 m0, 107520
    s_add_u32 s74, s73, 401408
    buffer_load_dwordx4 v14, s[40:43], s74 offen  lds
    s_mov_b32 m0, 108544
    s_add_u32 s74, s73, 458752
    buffer_load_dwordx4 v14, s[40:43], s74 offen  lds
    s_mov_b32 m0, 109568
    s_add_u32 s74, s73, 516096
    buffer_load_dwordx4 v14, s[40:43], s74 offen  lds
    s_mov_b32 m0, 110592
    s_add_u32 s74, s73, 573440
    buffer_load_dwordx4 v14, s[40:43], s74 offen  lds
    s_mov_b32 m0, 111616
    s_add_u32 s74, s73, 630784
    buffer_load_dwordx4 v14, s[40:43], s74 offen  lds
    s_mov_b32 m0, 112640
    s_add_u32 s74, s73, 688128
    buffer_load_dwordx4 v14, s[40:43], s74 offen  lds
    s_mov_b32 m0, 113664
    s_add_u32 s74, s73, 745472
    buffer_load_dwordx4 v14, s[40:43], s74 offen  lds
    s_mov_b32 m0, 114688
    s_add_u32 s74, s73, 802816
    buffer_load_dwordx4 v14, s[40:43], s74 offen  lds
    s_mov_b32 m0, 115712
    s_add_u32 s74, s73, 860160
    buffer_load_dwordx4 v14, s[40:43], s74 offen  lds
    s_mov_b32 m0, 116736
    s_add_u32 s74, s73, 917504
    buffer_load_dwordx4 v14, s[40:43], s74 offen  lds
    s_mov_b32 m0, 117760
    s_add_u32 s74, s73, 974848
    buffer_load_dwordx4 v14, s[40:43], s74 offen  lds
    s_mov_b32 m0, 118784
    s_add_u32 s74, s73, 1032192
    buffer_load_dwordx4 v14, s[40:43], s74 offen  lds
    s_mov_b32 m0, 119808
    s_add_u32 s74, s73, 1089536
    buffer_load_dwordx4 v14, s[40:43], s74 offen  lds
    s_mov_b32 m0, 120832
    s_add_u32 s74, s73, 1146880
    buffer_load_dwordx4 v14, s[40:43], s74 offen  lds
    s_mov_b32 m0, 121856
    s_add_u32 s74, s73, 1204224
    buffer_load_dwordx4 v14, s[40:43], s74 offen  lds
    s_mov_b32 m0, 122880
    s_add_u32 s74, s73, 1261568
    buffer_load_dwordx4 v14, s[40:43], s74 offen  lds
    s_mov_b32 m0, 123904
    s_add_u32 s74, s73, 1318912
    buffer_load_dwordx4 v14, s[40:43], s74 offen  lds
    s_mov_b32 m0, 124928
    s_add_u32 s74, s73, 1376256
    buffer_load_dwordx4 v14, s[40:43], s74 offen  lds
    s_mov_b32 m0, 125952
    s_add_u32 s74, s73, 1433600
    buffer_load_dwordx4 v14, s[40:43], s74 offen  lds
    s_mov_b32 m0, 126976
    s_add_u32 s74, s73, 1490944
    buffer_load_dwordx4 v14, s[40:43], s74 offen  lds
    s_mov_b32 m0, 128000
    s_add_u32 s74, s73, 1548288
    buffer_load_dwordx4 v14, s[40:43], s74 offen  lds
    s_mov_b64 exec, -1
L_pro:
    s_setprio 3
    s_add_u32 s61, s59, 0
    buffer_load_dwordx4 v[64:67], v1, s[28:31], s61 offen offset:0 nt
    buffer_load_dwordx4 v[68:71], v1, s[28:31], s61 offen offset:256 nt
    buffer_load_dwordx4 v[72:75], v1, s[28:31], s61 offen offset:2048 nt
    buffer_load_dwordx4 v[76:79], v1, s[28:31], s61 offen offset:2304 nt
    buffer_load_dwordx4 v[80:83], v2, s[28:31], s61 offen offset:0 nt
    buffer_load_dwordx4 v[84:87], v2, s[28:31], s61 offen offset:256 nt
    buffer_load_dwordx4 v[88:91], v2, s[28:31], s61 offen offset:2048 nt
    buffer_load_dwordx4 v[92:95], v2, s[28:31], s61 offen offset:2304 nt
    s_barrier
    s_add_u32 s61, s59, 65536
    buffer_load_dwordx4 v[96:99], v1, s[28:31], s61 offen offset:0 nt
    buffer_load_dwordx4 v[100:103], v1, s[28:31], s61 offen offset:256 nt
    buffer_load_dwordx4 v[104:107], v1, s[28:31], s61 offen offset:2048 nt
    buffer_load_dwordx4 v[108:111], v1, s[28:31], s61 offen offset:2304 nt
    buffer_load_dwordx4 v[112:115], v2, s[28:31], s61 offen offset:0 nt
    buffer_load_dwordx4 v[116:119], v2, s[28:31], s61 offen offset:256 nt
    buffer_load_dwordx4 v[120:123], v2, s[28:31], s61 offen offset:2048 nt
    buffer_load_dwordx4 v[124:127], v2, s[28:31], s61 offen offset:2304 nt
    s_waitcnt vmcnt(8)
    s_add_u32 s61, s59, 131072
    buffer_load_dwordx4 v[128:131], v1, s[28:31], s61 offen offset:0 nt
    buffer_load_dwordx4 v[132:135], v1, s[28:31], s61 offen offset:256 nt
    buffer_load_dwordx4 v[136:139], v1, s[28:31], s61 offen offset:2048 nt
    buffer_load_dwordx4 v[140:143], v1, s[28:31], s61 offen offset:2304 nt
    buffer_load_dwordx4 v[144:147], v2, s[28:31], s61 offen offset:0 nt
    buffer_load_dwordx4 v[148:151], v2, s[28:31], s61 offen offset:256 nt
    buffer_load_dwordx4 v[152:155], v2, s[28:31], s61 offen offset:2048 nt
    buffer_load_dwordx4 v[156:159], v2, s[28:31], s61 offen offset:2304 nt
    s_waitcnt vmcnt(8)
    s_add_u32 s61, s59, 196608
    buffer_load_dwordx4 v[160:163], v1, s[28:31], s61 offen offset:0 nt
    buffer_load_dwordx4 v[164:167], v1, s[28:31], s61 offen offset:256 nt
    buffer_load_dwordx4 v[168:171], v1, s[28:31], s61 offen offset:2048 nt
    buffer_load_dwordx4 v[172:175], v1, s[28:31], s61 offen offset:2304 nt
    buffer_load_dwordx4 v[176:179], v2, s[28:31], s61 offen offset:0 nt
    buffer_load_dwordx4 v[180:183], v2, s[28:31], s61 offen offset:256 nt
    buffer_load_dwordx4 v[184:187], v2, s[28:31], s61 offen offset:2048 nt
    buffer_load_dwordx4 v[188:191], v2, s[28:31], s61 offen offset:2304 nt
    s_waitcnt vmcnt(8)
    s_add_u32 s61, s59, 262144
    buffer_load_dwordx4 v[192:195], v1, s[28:31], s61 offen offset:0 nt
    buffer_load_dwordx4 v[196:199], v1, s[28:31], s61 offen offset:256 nt
    buffer_load_dwordx4 v[200:203], v1, s[28:31], s61 offen offset:2048 nt
    buffer_load_dwordx4 v[204:207], v1, s[28:31], s61 offen offset:2304 nt
    buffer_load_dwordx4 v[208:211], v2, s[28:31], s61 offen offset:0 nt
    buffer_load_dwordx4 v[212:215], v2, s[28:31], s61 offen offset:256 nt
    buffer_load_dwordx4 v[216:219], v2, s[28:31], s61 offen offset:2048 nt
    buffer_load_dwordx4 v[220:223], v2, s[28:31], s61 offen offset:2304 nt
    s_waitcnt vmcnt(8)
    s_add_u32 s61, s59, 327680
    buffer_load_dwordx4 v[224:227], v1, s[28:31], s61 offen offset:0 nt
    buffer_load_dwordx4 v[228:231], v1, s[28:31], s61 offen offset:256 nt
    buffer_load_dwordx4 v[232:235], v1, s[28:31], s61 offen offset:2048 nt
    buffer_load_dwordx4 v[236:239], v1, s[28:31], s61 offen offset:2304 nt
    buffer_load_dwordx4 v[240:243], v2, s[28:31], s61 offen offset:0 nt
    buffer_load_dwordx4 v[244:247], v2, s[28:31], s61 offen offset:256 nt
    buffer_load_dwordx4 v[248:251], v2, s[28:31], s61 offen offset:2048 nt
    buffer_load_dwordx4 v[252:255], v2, s[28:31], s61 offen offset:2304 nt
    s_cmp_eq_u32 s52, 1
    s_cbranch_scc1 L_w1
    s_cmp_eq_u32 s52, 2
    s_cbranch_scc1 L_gw
L_flag:
    v_mov_b32 v14, 153088
    s_nop 1
L_flag_loop:
    ds_read_b32 v15, v14
    s_waitcnt lgkmcnt(0)
    v_readfirstlane_b32 s85, v15
    s_nop 1
    s_cmp_lg_u32 s85, 0
    s_nop 1
    s_cbranch_scc1 L_main
    s_sleep 2
    s_branch L_flag_loop
L_w0:
    s_setprio 3
    buffer_load_dwordx2 v[8:9], v15, s[36:39], 0 offen
    v_lshrrev_b32 v14, 1, v0
    v_lshlrev_b32 v14, 13, v14
    v_and_b32 v15, 1, v0
    v_lshl_add_u32 v14, v15, 4, v14
    s_lshl_b32 s73, s53, 10
    s_lshl_b32 s74, s56, 5
    s_add_u32 s73, s73, s74
    s_mov_b32 m0, 86016
    s_add_u32 s74, s73, 0
    buffer_load_dwordx4 v14, s[40:43], s74 offen  lds
    s_mov_b32 m0, 87040
    s_add_u32 s74, s73, 262144
    buffer_load_dwordx4 v14, s[40:43], s74 offen  lds
    s_mov_b32 m0, 88064
    s_add_u32 s74, s73, 524288
    buffer_load_dwordx4 v14, s[40:43], s74 offen  lds
    s_mov_b32 m0, 89088
    s_add_u32 s74, s73, 786432
    buffer_load_dwordx4 v14, s[40:43], s74 offen  lds
    s_mov_b32 m0, 90112
    s_add_u32 s74, s73, 1048576
    buffer_load_dwordx4 v14, s[40:43], s74 offen  lds
    s_mov_b32 m0, 91136
    s_add_u32 s74, s73, 1310720
    buffer_load_dwordx4 v14, s[40:43], s74 offen  lds
    s_mov_b32 m0, 92160
    s_add_u32 s74, s73, 1572864
    buffer_load_dwordx4 v14, s[40:43], s74 offen  lds
    s_mov_b32 m0, 93184
    s_add_u32 s74, s73, 1835008
    buffer_load_dwordx4 v14, s[40:43], s74 offen  lds
    s_mov_b32 m0, 94208
    s_add_u32 s74, s73, 2097152
    buffer_load_dwordx4 v14, s[40:43], s74 offen  lds
    s_mov_b32 m0, 95232
    s_add_u32 s74, s73, 2359296
    buffer_load_dwordx4 v14, s[40:43], s74 offen  lds
    s_mov_b32 m0, 96256
    s_add_u32 s74, s73, 2621440
    buffer_load_dwordx4 v14, s[40:43], s74 offen  lds
    s_mov_b32 m0, 97280
    s_add_u32 s74, s73, 2883584
    buffer_load_dwordx4 v14, s[40:43], s74 offen  lds
    s_mov_b32 m0, 98304
    s_add_u32 s74, s73, 3145728
    buffer_load_dwordx4 v14, s[40:43], s74 offen  lds
    s_mov_b32 m0, 99328
    s_add_u32 s74, s73, 3407872
    buffer_load_dwordx4 v14, s[40:43], s74 offen  lds
    v_mul_u32_u24 v15, 896, v13
    v_lshl_add_u32 v15, v11, 4, v15
    buffer_load_dwordx4 v[64:67], v15, s[44:47], 0 offen offset:0
    buffer_load_dwordx4 v[68:71], v15, s[44:47], 0 offen offset:64
    buffer_load_dwordx4 v[72:75], v15, s[44:47], 0 offen offset:128
    buffer_load_dwordx4 v[76:79], v15, s[44:47], 0 offen offset:192
    buffer_load_dwordx4 v[80:83], v15, s[44:47], 0 offen offset:256
    buffer_load_dwordx4 v[84:87], v15, s[44:47], 0 offen offset:320
    buffer_load_dwordx4 v[88:91], v15, s[44:47], 0 offen offset:384
    buffer_load_dwordx4 v[92:95], v15, s[44:47], 0 offen offset:448
    buffer_load_dwordx4 v[96:99], v15, s[44:47], 0 offen offset:512
    buffer_load_dwordx4 v[100:103], v15, s[44:47], 0 offen offset:576
    buffer_load_dwordx4 v[104:107], v15, s[44:47], 0 offen offset:640
    buffer_load_dwordx4 v[108:111], v15, s[44:47], 0 offen offset:704
    buffer_load_dwordx4 v[112:115], v15, s[44:47], 0 offen offset:768
    buffer_load_dwordx4 v[116:119], v15, s[44:47], 0 offen offset:832
    s_barrier
    v_lshl_add_u32 v14, v11, 3, v12
    v_lshlrev_b32 v14, 5, v14
    v_lshl_add_u32 v14, v13, 3, v14
    v_add_u32 v14, 86016, v14
    s_waitcnt lgkmcnt(0)
    s_waitcnt vmcnt(0)
    v_add_co_u32 v8, vcc, 1, v8
    v_addc_co_u32 v9, vcc, 0, v9, vcc
    ds_read_b64_tr_b16 v[128:129], v14 offset:0
    ds_read_b64_tr_b16 v[130:131], v14 offset:128
    ds_read_b64_tr_b16 v[132:133], v14 offset:1024
    ds_read_b64_tr_b16 v[134:135], v14 offset:1152
    ds_read_b64_tr_b16 v[136:137], v14 offset:2048
    ds_read_b64_tr_b16 v[138:139], v14 offset:2176
    ds_read_b64_tr_b16 v[140:141], v14 offset:3072
    ds_read_b64_tr_b16 v[142:143], v14 offset:3200
    ds_read_b64_tr_b16 v[144:145], v14 offset:4096
    ds_read_b64_tr_b16 v[146:147], v14 offset:4224
    ds_read_b64_tr_b16 v[148:149], v14 offset:5120
    ds_read_b64_tr_b16 v[150:151], v14 offset:5248
    ds_read_b64_tr_b16 v[152:153], v14 offset:6144
    ds_read_b64_tr_b16 v[154:155], v14 offset:6272
    s_waitcnt lgkmcnt(0)
    ds_read_b64_tr_b16 v[156:157], v14 offset:7168
    ds_read_b64_tr_b16 v[158:159], v14 offset:7296
    ds_read_b64_tr_b16 v[160:161], v14 offset:8192
    ds_read_b64_tr_b16 v[162:163], v14 offset:8320
    ds_read_b64_tr_b16 v[164:165], v14 offset:9216
    ds_read_b64_tr_b16 v[166:167], v14 offset:9344
    ds_read_b64_tr_b16 v[168:169], v14 offset:10240
    ds_read_b64_tr_b16 v[170:171], v14 offset:10368
    ds_read_b64_tr_b16 v[172:173], v14 offset:11264
    ds_read_b64_tr_b16 v[174:175], v14 offset:11392
    ds_read_b64_tr_b16 v[176:177], v14 offset:12288
    ds_read_b64_tr_b16 v[178:179], v14 offset:12416
    ds_read_b64_tr_b16 v[180:181], v14 offset:13312
    ds_read_b64_tr_b16 v[182:183], v14 offset:13440
    s_waitcnt lgkmcnt(0)
    v_mfma_f32_16x16x32_bf16 v[48:51], v[128:131], v[64:67], 0
    v_mfma_f32_16x16x32_bf16 v[48:51], v[132:135], v[68:71], v[48:51]
    v_mfma_f32_16x16x32_bf16 v[48:51], v[136:139], v[72:75], v[48:51]
    v_mfma_f32_16x16x32_bf16 v[48:51], v[140:143], v[76:79], v[48:51]
    v_mfma_f32_16x16x32_bf16 v[48:51], v[144:147], v[80:83], v[48:51]
    v_mfma_f32_16x16x32_bf16 v[48:51], v[148:151], v[84:87], v[48:51]
    v_mfma_f32_16x16x32_bf16 v[48:51], v[152:155], v[88:91], v[48:51]
    v_mfma_f32_16x16x32_bf16 v[48:51], v[156:159], v[92:95], v[48:51]
    v_mfma_f32_16x16x32_bf16 v[48:51], v[160:163], v[96:99], v[48:51]
    v_mfma_f32_16x16x32_bf16 v[48:51], v[164:167], v[100:103], v[48:51]
    v_mfma_f32_16x16x32_bf16 v[48:51], v[168:171], v[104:107], v[48:51]
    v_mfma_f32_16x16x32_bf16 v[48:51], v[172:175], v[108:111], v[48:51]
    v_mfma_f32_16x16x32_bf16 v[48:51], v[176:179], v[112:115], v[48:51]
    v_mfma_f32_16x16x32_bf16 v[48:51], v[180:183], v[116:119], v[48:51]
    v_lshlrev_b32 v14, 14, v10
    v_lshl_add_u32 v14, v11, 4, v14
    s_lshl_b32 s73, s53, 11
    s_lshl_b32 s74, s56, 6
    s_add_u32 s73, s73, s74
    s_add_u32 s73, s73, 4096
    v_mov_b32 v54, v8
    v_mov_b32 v55, v9
    v_cvt_pk_bf16_f32 v52, v48, v49
    v_cvt_pk_bf16_f32 v53, v50, v51
    s_mov_b32 exec_lo, 0x000f000f
    s_mov_b32 exec_hi, 0x000f000f
    buffer_store_dwordx4 v[52:55], v14, s[36:39], s73 offen sc1
    s_mov_b64 exec, -1
    s_lshl_b32 s73, s57, 11
    s_add_u32 s73, s73, 4096
    s_mov_b32 s80, 0
    s_getreg_b32 s86, hwreg(HW_REG_XCC_ID)
    s_and_b32 s86, s86, 15
    s_lshl_b32 s87, s57, 7
    s_add_u32 s87, s87, 98304
    s_lshl_b32 s74, s55, 4
    s_add_u32 s74, s74, s87
    v_mov_b32 v48, s86
    v_mov_b32 v49, s86
    v_mov_b32 v50, v8
    v_mov_b32 v51, v9
    v_mov_b32 v15, 0
    s_mov_b64 exec, 1
    buffer_store_dwordx4 v[48:51], v15, s[36:39], s74 offen sc1
    s_mov_b64 exec, -1
    v_and_b32 v15, 7, v0
    v_lshlrev_b32 v15, 4, v15
    v_mov_b32 v15, 152896
    ds_write_b64 v15, v[8:9]
    v_mov_b32 v15, 153088
    v_mov_b32 v14, 1
    s_waitcnt lgkmcnt(0)
    ds_write_b32 v15, v14 offset:4
    s_add_u32 s61, s59, 0
    buffer_load_dwordx4 v[64:67], v1, s[28:31], s61 offen offset:0 nt
    buffer_load_dwordx4 v[68:71], v1, s[28:31], s61 offen offset:256 nt
    buffer_load_dwordx4 v[72:75], v1, s[28:31], s61 offen offset:2048 nt
    buffer_load_dwordx4 v[76:79], v1, s[28:31], s61 offen offset:2304 nt
    buffer_load_dwordx4 v[80:83], v2, s[28:31], s61 offen offset:0 nt
    buffer_load_dwordx4 v[84:87], v2, s[28:31], s61 offen offset:256 nt
    buffer_load_dwordx4 v[88:91], v2, s[28:31], s61 offen offset:2048 nt
    buffer_load_dwordx4 v[92:95], v2, s[28:31], s61 offen offset:2304 nt
    s_add_u32 s61, s59, 65536
    buffer_load_dwordx4 v[96:99], v1, s[28:31], s61 offen offset:0 nt
    buffer_load_dwordx4 v[100:103], v1, s[28:31], s61 offen offset:256 nt
    buffer_load_dwordx4 v[104:107], v1, s[28:31], s61 offen offset:2048 nt
    buffer_load_dwordx4 v[108:111], v1, s[28:31], s61 offen offset:2304 nt
    buffer_load_dwordx4 v[112:115], v2, s[28:31], s61 offen offset:0 nt
    buffer_load_dwordx4 v[116:119], v2, s[28:31], s61 offen offset:256 nt
    buffer_load_dwordx4 v[120:123], v2, s[28:31], s61 offen offset:2048 nt
    buffer_load_dwordx4 v[124:127], v2, s[28:31], s61 offen offset:2304 nt
    s_waitcnt vmcnt(8)
    s_add_u32 s61, s59, 131072
    buffer_load_dwordx4 v[128:131], v1, s[28:31], s61 offen offset:0 nt
    buffer_load_dwordx4 v[132:135], v1, s[28:31], s61 offen offset:256 nt
    buffer_load_dwordx4 v[136:139], v1, s[28:31], s61 offen offset:2048 nt
    buffer_load_dwordx4 v[140:143], v1, s[28:31], s61 offen offset:2304 nt
    buffer_load_dwordx4 v[144:147], v2, s[28:31], s61 offen offset:0 nt
    buffer_load_dwordx4 v[148:151], v2, s[28:31], s61 offen offset:256 nt
    buffer_load_dwordx4 v[152:155], v2, s[28:31], s61 offen offset:2048 nt
    buffer_load_dwordx4 v[156:159], v2, s[28:31], s61 offen offset:2304 nt
    s_waitcnt vmcnt(8)
    s_add_u32 s61, s59, 196608
    buffer_load_dwordx4 v[160:163], v1, s[28:31], s61 offen offset:0 nt
    buffer_load_dwordx4 v[164:167], v1, s[28:31], s61 offen offset:256 nt
    buffer_load_dwordx4 v[168:171], v1, s[28:31], s61 offen offset:2048 nt
    buffer_load_dwordx4 v[172:175], v1, s[28:31], s61 offen offset:2304 nt
    buffer_load_dwordx4 v[176:179], v2, s[28:31], s61 offen offset:0 nt
    buffer_load_dwordx4 v[180:183], v2, s[28:31], s61 offen offset:256 nt
    buffer_load_dwordx4 v[184:187], v2, s[28:31], s61 offen offset:2048 nt
    buffer_load_dwordx4 v[188:191], v2, s[28:31], s61 offen offset:2304 nt
    s_waitcnt vmcnt(8)
    s_add_u32 s61, s59, 262144
    buffer_load_dwordx4 v[192:195], v1, s[28:31], s61 offen offset:0 nt
    buffer_load_dwordx4 v[196:199], v1, s[28:31], s61 offen offset:256 nt
    buffer_load_dwordx4 v[200:203], v1, s[28:31], s61 offen offset:2048 nt
    buffer_load_dwordx4 v[204:207], v1, s[28:31], s61 offen offset:2304 nt
    buffer_load_dwordx4 v[208:211], v2, s[28:31], s61 offen offset:0 nt
    buffer_load_dwordx4 v[212:215], v2, s[28:31], s61 offen offset:256 nt
    buffer_load_dwordx4 v[216:219], v2, s[28:31], s61 offen offset:2048 nt
    buffer_load_dwordx4 v[220:223], v2, s[28:31], s61 offen offset:2304 nt
    s_waitcnt vmcnt(8)
    s_add_u32 s61, s59, 327680
    buffer_load_dwordx4 v[224:227], v1, s[28:31], s61 offen offset:0 nt
    buffer_load_dwordx4 v[228:231], v1, s[28:31], s61 offen offset:256 nt
    buffer_load_dwordx4 v[232:235], v1, s[28:31], s61 offen offset:2048 nt
    buffer_load_dwordx4 v[236:239], v1, s[28:31], s61 offen offset:2304 nt
    buffer_load_dwordx4 v[240:243], v2, s[28:31], s61 offen offset:0 nt
    buffer_load_dwordx4 v[244:247], v2, s[28:31], s61 offen offset:256 nt
    buffer_load_dwordx4 v[248:251], v2, s[28:31], s61 offen offset:2048 nt
    buffer_load_dwordx4 v[252:255], v2, s[28:31], s61 offen offset:2304 nt
    s_branch L_flag
L_gw:
    s_getreg_b32 s86, hwreg(HW_REG_XCC_ID)
    s_and_b32 s86, s86, 15
    s_lshl_b32 s87, s57, 7
    s_add_u32 s87, s87, 98304
    s_lshl_b32 s73, s57, 11
    s_add_u32 s73, s73, 4096
    v_mov_b32 v14, 153088
    s_nop 1
L_gw_tag:
    ds_read_b32 v15, v14 offset:4
    s_waitcnt lgkmcnt(0)
    v_readfirstlane_b32 s85, v15
    s_nop 1
    s_cmp_lg_u32 s85, 0
    s_nop 1
    s_cbranch_scc1 L_gw_go
    s_sleep 1
    s_branch L_gw_tag
L_gw_go:
    v_mov_b32 v15, 152896
    ds_read_b64 v[8:9], v15
    v_and_b32 v15, 7, v0
    v_lshlrev_b32 v15, 4, v15
    s_waitcnt lgkmcnt(0)
    s_mov_b32 s80, 0
L_w0_poll:
    buffer_load_dwordx4 v[48:51], v3, s[36:39], s73 offen offset:0 sc1
    buffer_load_dwordx4 v[52:55], v3, s[36:39], s73 offen offset:1024 sc1
    buffer_load_dwordx4 v[56:59], v15, s[36:39], s87 offen sc1
    s_waitcnt vmcnt(0)
    v_cmp_eq_u64 s[76:77], v[50:51], v[8:9]
    v_cmp_eq_u64 s[78:79], v[54:55], v[8:9]
    s_nop 1
    s_and_b64 s[76:77], s[76:77], s[78:79]
    v_cmp_eq_u64 s[78:79], v[58:59], v[8:9]
    s_nop 1
    s_and_b64 s[76:77], s[76:77], s[78:79]
    s_cmp_eq_u64 s[76:77], exec
    s_nop 0
    s_cbranch_scc1 L_w0_poll_g0
    s_add_u32 s80, s80, 1
    s_cmp_lt_u32 s80, 400000
    s_cbranch_scc1 L_w0_poll
L_w0_poll_g0:
L_w0_poll_got:
    v_cmp_eq_u32 s[76:77], s86, v56
    s_nop 1
    s_cmp_eq_u64 s[76:77], exec
    s_cselect_b32 s85, 2, 1
    v_lshlrev_b32 v14, 3, v0
    v_add_u32 v14, 151552, v14
    ds_write_b64 v14, v[48:49]
    ds_write_b64 v14, v[52:53] offset:512
    v_mov_b32 v15, 152896
    ds_write_b64 v15, v[8:9]
    v_mov_b32 v15, 153088
    v_mov_b32 v14, s85
    s_waitcnt lgkmcnt(0)
    ds_write_b32 v15, v14
    s_branch L_main
L_w1:
    v_lshl_add_u32 v14, v11, 3, v12
    v_lshlrev_b32 v14, 6, v14
    v_lshl_add_u32 v14, v13, 3, v14
    v_add_u32 v14, 100352, v14
    v_lshlrev_b32 v15, 4, v11
    v_add_u32 v15, 153152, v15
    s_waitcnt vmcnt(48)
    ds_read_b128 v[16:19], v15 offset:0
    ds_read_b64_tr_b16 v[24:25], v14 offset:0
    ds_read_b64_tr_b16 v[26:27], v14 offset:256
    ds_read_b64_tr_b16 v[28:29], v14 offset:32
    ds_read_b64_tr_b16 v[30:31], v14 offset:288
    s_mov_b32 s74, 0xffff0000
    v_mov_b32 v40, 0
    v_lshlrev_b32 v41, 16, v56
    v_lshlrev_b32 v42, 16, v60
    v_fmac_f32 v40, v41, v42
    v_and_b32 v41, s74, v56
    v_and_b32 v42, s74, v60
    v_fmac_f32 v40, v41, v42
    v_lshlrev_b32 v41, 16, v57
    v_lshlrev_b32 v42, 16, v61
    v_fmac_f32 v40, v41, v42
    v_and_b32 v41, s74, v57
    v_and_b32 v42, s74, v61
    v_fmac_f32 v40, v41, v42
    v_lshlrev_b32 v41, 16, v58
    v_lshlrev_b32 v42, 16, v62
    v_fmac_f32 v40, v41, v42
    v_and_b32 v41, s74, v58
    v_and_b32 v42, s74, v62
    v_fmac_f32 v40, v41, v42
    v_lshlrev_b32 v41, 16, v59
    v_lshlrev_b32 v42, 16, v63
    v_fmac_f32 v40, v41, v42
    v_and_b32 v41, s74, v59
    v_and_b32 v42, s74, v63
    v_fmac_f32 v40, v41, v42
    v_cmp_gt_u32 vcc, 56, v0
    s_nop 1
    v_cndmask_b32 v40, 0, v40, vcc
    ds_read_b128 v[20:23], v15 offset:64
    ds_read_b64_tr_b16 v[32:33], v14 offset:2048
    ds_read_b64_tr_b16 v[34:35], v14 offset:2304
    ds_read_b64_tr_b16 v[36:37], v14 offset:2080
    ds_read_b64_tr_b16 v[38:39], v14 offset:2336
    s_waitcnt lgkmcnt(5)
    v_mfma_f32_16x16x32_bf16 v[48:51], v[24:27], v[16:19], 0
    v_mfma_f32_16x16x32_bf16 v[52:55], v[28:31], v[16:19], 0
    ds_read_b128 v[16:19], v15 offset:128
    ds_read_b64_tr_b16 v[24:25], v14 offset:4096
    ds_read_b64_tr_b16 v[26:27], v14 offset:4352
    ds_read_b64_tr_b16 v[28:29], v14 offset:4128
    ds_read_b64_tr_b16 v[30:31], v14 offset:4384
    s_waitcnt lgkmcnt(5)
    v_mfma_f32_16x16x32_bf16 v[48:51], v[32:35], v[20:23], v[48:51]
    v_mfma_f32_16x16x32_bf16 v[52:55], v[36:39], v[20:23], v[52:55]
    ds_read_b128 v[20:23], v15 offset:192
    ds_read_b64_tr_b16 v[32:33], v14 offset:6144
    ds_read_b64_tr_b16 v[34:35], v14 offset:6400
    ds_read_b64_tr_b16 v[36:37], v14 offset:6176
    ds_read_b64_tr_b16 v[38:39], v14 offset:6432
    s_waitcnt lgkmcnt(5)
    v_mfma_f32_16x16x32_bf16 v[48:51], v[24:27], v[16:19], v[48:51]
    v_mfma_f32_16x16x32_bf16 v[52:55], v[28:31], v[16:19], v[52:55]
    ds_read_b128 v[16:19], v15 offset:256
    ds_read_b64_tr_b16 v[24:25], v14 offset:8192
    ds_read_b64_tr_b16 v[26:27], v14 offset:8448
    ds_read_b64_tr_b16 v[28:29], v14 offset:8224
    ds_read_b64_tr_b16 v[30:31], v14 offset:8480
    s_waitcnt lgkmcnt(5)
    v_mfma_f32_16x16x32_bf16 v[48:51], v[32:35], v[20:23], v[48:51]
    v_mfma_f32_16x16x32_bf16 v[52:55], v[36:39], v[20:23], v[52:55]
    ds_read_b128 v[20:23], v15 offset:320
    ds_read_b64_tr_b16 v[32:33], v14 offset:10240
    ds_read_b64_tr_b16 v[34:35], v14 offset:10496
    ds_read_b64_tr_b16 v[36:37], v14 offset:10272
    ds_read_b64_tr_b16 v[38:39], v14 offset:10528
    s_waitcnt lgkmcnt(5)
    v_mfma_f32_16x16x32_bf16 v[48:51], v[24:27], v[16:19], v[48:51]
    v_mfma_f32_16x16x32_bf16 v[52:55], v[28:31], v[16:19], v[52:55]
    ds_read_b128 v[16:19], v15 offset:384
    ds_read_b64_tr_b16 v[24:25], v14 offset:12288
    ds_read_b64_tr_b16 v[26:27], v14 offset:12544
    ds_read_b64_tr_b16 v[28:29], v14 offset:12320
    ds_read_b64_tr_b16 v[30:31], v14 offset:12576
    s_waitcnt lgkmcnt(5)
    v_mfma_f32_16x16x32_bf16 v[48:51], v[32:35], v[20:23], v[48:51]
    v_mfma_f32_16x16x32_bf16 v[52:55], v[36:39], v[20:23], v[52:55]
    ds_read_b128 v[20:23], v15 offset:448
    ds_read_b64_tr_b16 v[32:33], v14 offset:14336
    ds_read_b64_tr_b16 v[34:35], v14 offset:14592
    ds_read_b64_tr_b16 v[36:37], v14 offset:14368
    ds_read_b64_tr_b16 v[38:39], v14 offset:14624
    s_waitcnt lgkmcnt(5)
    v_mfma_f32_16x16x32_bf16 v[48:51], v[24:27], v[16:19], v[48:51]
    v_mfma_f32_16x16x32_bf16 v[52:55], v[28:31], v[16:19], v[52:55]
    ds_read_b128 v[16:19], v15 offset:512
    ds_read_b64_tr_b16 v[24:25], v14 offset:16384
    ds_read_b64_tr_b16 v[26:27], v14 offset:16640
    ds_read_b64_tr_b16 v[28:29], v14 offset:16416
    ds_read_b64_tr_b16 v[30:31], v14 offset:16672
    s_waitcnt lgkmcnt(5)
    v_mfma_f32_16x16x32_bf16 v[48:51], v[32:35], v[20:23], v[48:51]
    v_mfma_f32_16x16x32_bf16 v[52:55], v[36:39], v[20:23], v[52:55]
    ds_read_b128 v[20:23], v15 offset:576
    ds_read_b64_tr_b16 v[32:33], v14 offset:18432
    ds_read_b64_tr_b16 v[34:35], v14 offset:18688
    ds_read_b64_tr_b16 v[36:37], v14 offset:18464
    ds_read_b64_tr_b16 v[38:39], v14 offset:18720
    s_waitcnt lgkmcnt(5)
    v_mfma_f32_16x16x32_bf16 v[48:51], v[24:27], v[16:19], v[48:51]
    v_mfma_f32_16x16x32_bf16 v[52:55], v[28:31], v[16:19], v[52:55]
    ds_read_b128 v[16:19], v15 offset:640
    ds_read_b64_tr_b16 v[24:25], v14 offset:20480
    ds_read_b64_tr_b16 v[26:27], v14 offset:20736
    ds_read_b64_tr_b16 v[28:29], v14 offset:20512
    ds_read_b64_tr_b16 v[30:31], v14 offset:20768
    s_waitcnt lgkmcnt(5)
    v_mfma_f32_16x16x32_bf16 v[48:51], v[32:35], v[20:23], v[48:51]
    v_mfma_f32_16x16x32_bf16 v[52:55], v[36:39], v[20:23], v[52:55]
    ds_read_b128 v[20:23], v15 offset:704
    ds_read_b64_tr_b16 v[32:33], v14 offset:22528
    ds_read_b64_tr_b16 v[34:35], v14 offset:22784
    ds_read_b64_tr_b16 v[36:37], v14 offset:22560
    ds_read_b64_tr_b16 v[38:39], v14 offset:22816
    s_waitcnt lgkmcnt(5)
    v_mfma_f32_16x16x32_bf16 v[48:51], v[24:27], v[16:19], v[48:51]
    v_mfma_f32_16x16x32_bf16 v[52:55], v[28:31], v[16:19], v[52:55]
    ds_read_b128 v[16:19], v15 offset:768
    ds_read_b64_tr_b16 v[24:25], v14 offset:24576
    ds_read_b64_tr_b16 v[26:27], v14 offset:24832
    ds_read_b64_tr_b16 v[28:29], v14 offset:24608
    ds_read_b64_tr_b16 v[30:31], v14 offset:24864
    s_waitcnt lgkmcnt(5)
    v_mfma_f32_16x16x32_bf16 v[48:51], v[32:35], v[20:23], v[48:51]
    v_mfma_f32_16x16x32_bf16 v[52:55], v[36:39], v[20:23], v[52:55]
    ds_read_b128 v[20:23], v15 offset:832
    ds_read_b64_tr_b16 v[32:33], v14 offset:26624
    ds_read_b64_tr_b16 v[34:35], v14 offset:26880
    ds_read_b64_tr_b16 v[36:37], v14 offset:26656
    ds_read_b64_tr_b16 v[38:39], v14 offset:26912
    s_waitcnt lgkmcnt(5)
    v_mfma_f32_16x16x32_bf16 v[48:51], v[24:27], v[16:19], v[48:51]
    v_mfma_f32_16x16x32_bf16 v[52:55], v[28:31], v[16:19], v[52:55]
    s_waitcnt lgkmcnt(0)
    v_mfma_f32_16x16x32_bf16 v[48:51], v[32:35], v[20:23], v[48:51]
    v_mfma_f32_16x16x32_bf16 v[52:55], v[36:39], v[20:23], v[52:55]
    v_add_f32_dpp v40, v40, v40 row_ror:8 row_mask:0xf bank_mask:0xf
    s_nop 1
    v_add_f32_dpp v40, v40, v40 row_ror:4 row_mask:0xf bank_mask:0xf
    s_nop 1
    v_add_f32_dpp v40, v40, v40 row_ror:2 row_mask:0xf bank_mask:0xf
    s_nop 1
    v_add_f32_dpp v40, v40, v40 row_ror:1 row_mask:0xf bank_mask:0xf
    v_mov_b32 v41, v40
    s_nop 1
    v_permlane16_swap_b32 v40, v41
    v_add_f32 v40, v40, v41
    v_mov_b32 v41, v40
    s_nop 1
    v_permlane32_swap_b32 v40, v41
    v_add_f32 v40, v40, v41
    v_mul_f32 v40, 0xbfb8aa3b, v40
    v_exp_f32 v40, v40
    s_nop 0
    v_add_f32 v40, 1.0, v40
    v_rcp_f32 v40, v40
    s_nop 0
    v_sub_f32 v41, 1.0, v40
    s_cmp_lt_u32 s91, 56
    s_cselect_b64 s[76:77], -1, 0
    v_mov_b32 v15, 152904
    ds_write_b32 v15, v40
    v_max_f32 v48, 0, v48
    v_mul_f32 v48, v41, v48
    v_cndmask_b32 v48, 0, v48, s[76:77]
    v_max_f32 v49, 0, v49
    v_mul_f32 v49, v41, v49
    v_cndmask_b32 v49, 0, v49, s[76:77]
    v_max_f32 v50, 0, v50
    v_mul_f32 v50, v41, v50
    v_cndmask_b32 v50, 0, v50, s[76:77]
    v_max_f32 v51, 0, v51
    v_mul_f32 v51, v41, v51
    v_cndmask_b32 v51, 0, v51, s[76:77]
    v_max_f32 v52, 0, v52
    v_mul_f32 v52, v41, v52
    v_cndmask_b32 v52, 0, v52, s[76:77]
    v_max_f32 v53, 0, v53
    v_mul_f32 v53, v41, v53
    v_cndmask_b32 v53, 0, v53, s[76:77]
    v_max_f32 v54, 0, v54
    v_mul_f32 v54, v41, v54
    v_cndmask_b32 v54, 0, v54, s[76:77]
    v_max_f32 v55, 0, v55
    v_mul_f32 v55, v41, v55
    v_cndmask_b32 v55, 0, v55, s[76:77]
    v_cvt_pk_bf16_f32 v56, v48, v49
    v_cvt_pk_bf16_f32 v57, v50, v51
    v_cvt_pk_bf16_f32 v58, v52, v53
    v_cvt_pk_bf16_f32 v59, v54, v55
    v_lshlrev_b32 v14, 3, v11
    v_add_u32 v14, 152704, v14
    s_mov_b32 exec_lo, 0x00010001
    s_mov_b32 exec_hi, 0x00010001
    ds_write_b64 v14, v[56:57]
    ds_write_b64 v14, v[58:59] offset:32
    s_mov_b64 exec, -1
    s_branch L_flag
L_main:
    v_mov_b32 v15, 152896
    ds_read_b64 v[8:9], v15
    v_bfe_u32 v14, v10, 2, 1
    v_lshlrev_b32 v14, 9, v14
    v_lshl_add_u32 v14, v11, 6, v14
    v_lshl_add_u32 v14, v13, 4, v14
    v_add_u32 v14, 151552, v14
    ds_read_b128 v[16:19], v14
    ds_read_b128 v[20:23], v14 offset:256
    s_mov_b32 s40, s12
    s_mov_b32 s41, s13
    s_mov_b32 s42, 3670016
    s_mov_b32 s44, s18
    s_mov_b32 s45, s19
    s_mov_b32 s46, 1605632
    s_mov_b32 s81, 0x3db8aa3b
    s_sub_u32 s90, s52, 1
    s_cmp_lt_u32 s90, 3
    s_cselect_b32 s90, 1, 0
    s_waitcnt lgkmcnt(0)
    s_waitcnt vmcnt(40)
    v_mfma_f32_16x16x32_bf16 v[48:51], v[16:19], v[64:67], 0
    v_mfma_f32_16x16x32_bf16 v[52:55], v[16:19], v[72:75], 0
    v_mfma_f32_16x16x32_bf16 v[56:59], v[16:19], v[80:83], 0
    v_mfma_f32_16x16x32_bf16 v[60:63], v[16:19], v[88:91], 0
    v_mfma_f32_16x16x32_bf16 v[48:51], v[20:23], v[68:71], v[48:51]
    v_mfma_f32_16x16x32_bf16 v[52:55], v[20:23], v[76:79], v[52:55]
    v_mfma_f32_16x16x32_bf16 v[56:59], v[20:23], v[84:87], v[56:59]
    v_mfma_f32_16x16x32_bf16 v[60:63], v[20:23], v[92:95], v[60:63]
    s_add_u32 s61, s59, 393216
    buffer_load_dwordx4 v[64:67], v1, s[28:31], s61 offen offset:0 nt
    buffer_load_dwordx4 v[68:71], v1, s[28:31], s61 offen offset:256 nt
    buffer_load_dwordx4 v[72:75], v1, s[28:31], s61 offen offset:2048 nt
    buffer_load_dwordx4 v[76:79], v1, s[28:31], s61 offen offset:2304 nt
    buffer_load_dwordx4 v[80:83], v2, s[28:31], s61 offen offset:0 nt
    buffer_load_dwordx4 v[84:87], v2, s[28:31], s61 offen offset:256 nt
    buffer_load_dwordx4 v[88:91], v2, s[28:31], s61 offen offset:2048 nt
    buffer_load_dwordx4 v[92:95], v2, s[28:31], s61 offen offset:2304 nt
    v_cndmask_b32 v32, v48, v49, s[62:63]
    v_cndmask_b32 v33, v52, v53, s[62:63]
    v_cndmask_b32 v34, v56, v57, s[62:63]
    v_cndmask_b32 v35, v60, v61, s[62:63]
    v_cndmask_b32 v32, v32, v50, s[64:65]
    v_cndmask_b32 v33, v33, v54, s[64:65]
    v_cndmask_b32 v34, v34, v58, s[64:65]
    v_cndmask_b32 v35, v35, v62, s[64:65]
    v_cndmask_b32 v32, v32, v51, s[66:67]
    v_cndmask_b32 v33, v33, v55, s[66:67]
    v_cndmask_b32 v34, v34, v59, s[66:67]
    v_cndmask_b32 v35, v35, v63, s[66:67]
    v_add_f32_dpp v32, v32, v32 quad_perm:[1,0,3,2] row_mask:0xf bank_mask:0xf
    v_add_f32_dpp v33, v33, v33 quad_perm:[1,0,3,2] row_mask:0xf bank_mask:0xf
    v_add_f32_dpp v34, v34, v34 quad_perm:[1,0,3,2] row_mask:0xf bank_mask:0xf
    v_add_f32_dpp v35, v35, v35 quad_perm:[1,0,3,2] row_mask:0xf bank_mask:0xf
    v_add_f32_dpp v32, v32, v32 quad_perm:[2,3,0,1] row_mask:0xf bank_mask:0xf
    v_add_f32_dpp v33, v33, v33 quad_perm:[2,3,0,1] row_mask:0xf bank_mask:0xf
    v_add_f32_dpp v34, v34, v34 quad_perm:[2,3,0,1] row_mask:0xf bank_mask:0xf
    v_add_f32_dpp v35, v35, v35 quad_perm:[2,3,0,1] row_mask:0xf bank_mask:0xf
    v_cndmask_b32 v24, v32, v33, s[62:63]
    v_cndmask_b32 v24, v24, v34, s[64:65]
    v_cndmask_b32 v24, v24, v35, s[66:67]
    s_waitcnt vmcnt(40)
    v_mfma_f32_16x16x32_bf16 v[48:51], v[16:19], v[96:99], 0
    v_mfma_f32_16x16x32_bf16 v[52:55], v[16:19], v[104:107], 0
    v_mfma_f32_16x16x32_bf16 v[56:59], v[16:19], v[112:115], 0
    v_mfma_f32_16x16x32_bf16 v[60:63], v[16:19], v[120:123], 0
    v_mfma_f32_16x16x32_bf16 v[48:51], v[20:23], v[100:103], v[48:51]
    v_mfma_f32_16x16x32_bf16 v[52:55], v[20:23], v[108:111], v[52:55]
    v_mfma_f32_16x16x32_bf16 v[56:59], v[20:23], v[116:119], v[56:59]
    v_mfma_f32_16x16x32_bf16 v[60:63], v[20:23], v[124:127], v[60:63]
    s_add_u32 s61, s59, 458752
    buffer_load_dwordx4 v[96:99], v1, s[28:31], s61 offen offset:0 nt
    buffer_load_dwordx4 v[100:103], v1, s[28:31], s61 offen offset:256 nt
    buffer_load_dwordx4 v[104:107], v1, s[28:31], s61 offen offset:2048 nt
    buffer_load_dwordx4 v[108:111], v1, s[28:31], s61 offen offset:2304 nt
    buffer_load_dwordx4 v[112:115], v2, s[28:31], s61 offen offset:0 nt
    buffer_load_dwordx4 v[116:119], v2, s[28:31], s61 offen offset:256 nt
    buffer_load_dwordx4 v[120:123], v2, s[28:31], s61 offen offset:2048 nt
    buffer_load_dwordx4 v[124:127], v2, s[28:31], s61 offen offset:2304 nt
    v_cndmask_b32 v32, v48, v49, s[62:63]
    v_cndmask_b32 v33, v52, v53, s[62:63]
    v_cndmask_b32 v34, v56, v57, s[62:63]
    v_cndmask_b32 v35, v60, v61, s[62:63]
    v_cndmask_b32 v32, v32, v50, s[64:65]
    v_cndmask_b32 v33, v33, v54, s[64:65]
    v_cndmask_b32 v34, v34, v58, s[64:65]
    v_cndmask_b32 v35, v35, v62, s[64:65]
    v_cndmask_b32 v32, v32, v51, s[66:67]
    v_cndmask_b32 v33, v33, v55, s[66:67]
    v_cndmask_b32 v34, v34, v59, s[66:67]
    v_cndmask_b32 v35, v35, v63, s[66:67]
    v_add_f32_dpp v32, v32, v32 quad_perm:[1,0,3,2] row_mask:0xf bank_mask:0xf
    v_add_f32_dpp v33, v33, v33 quad_perm:[1,0,3,2] row_mask:0xf bank_mask:0xf
    v_add_f32_dpp v34, v34, v34 quad_perm:[1,0,3,2] row_mask:0xf bank_mask:0xf
    v_add_f32_dpp v35, v35, v35 quad_perm:[1,0,3,2] row_mask:0xf bank_mask:0xf
    v_add_f32_dpp v32, v32, v32 quad_perm:[2,3,0,1] row_mask:0xf bank_mask:0xf
    v_add_f32_dpp v33, v33, v33 quad_perm:[2,3,0,1] row_mask:0xf bank_mask:0xf
    v_add_f32_dpp v34, v34, v34 quad_perm:[2,3,0,1] row_mask:0xf bank_mask:0xf
    v_add_f32_dpp v35, v35, v35 quad_perm:[2,3,0,1] row_mask:0xf bank_mask:0xf
    v_cndmask_b32 v25, v32, v33, s[62:63]
    v_cndmask_b32 v25, v25, v34, s[64:65]
    v_cndmask_b32 v25, v25, v35, s[66:67]
    s_waitcnt vmcnt(40)
    v_mfma_f32_16x16x32_bf16 v[48:51], v[16:19], v[128:131], 0
    v_mfma_f32_16x16x32_bf16 v[52:55], v[16:19], v[136:139], 0
    v_mfma_f32_16x16x32_bf16 v[56:59], v[16:19], v[144:147], 0
    v_mfma_f32_16x16x32_bf16 v[60:63], v[16:19], v[152:155], 0
    v_mfma_f32_16x16x32_bf16 v[48:51], v[20:23], v[132:135], v[48:51]
    v_mfma_f32_16x16x32_bf16 v[52:55], v[20:23], v[140:143], v[52:55]
    v_mfma_f32_16x16x32_bf16 v[56:59], v[20:23], v[148:151], v[56:59]
    v_mfma_f32_16x16x32_bf16 v[60:63], v[20:23], v[156:159], v[60:63]
    s_add_u32 s61, s59, 0
    buffer_load_dwordx4 v[128:131], v3, s[32:35], s61 offen offset:0 nt
    buffer_load_dwordx4 v[132:135], v3, s[32:35], s61 offen offset:1024 nt
    buffer_load_dwordx4 v[136:139], v3, s[32:35], s61 offen offset:2048 nt
    buffer_load_dwordx4 v[140:143], v3, s[32:35], s61 offen offset:3072 nt
    buffer_load_dwordx4 v[144:147], v4, s[32:35], s61 offen offset:0 nt
    buffer_load_dwordx4 v[148:151], v4, s[32:35], s61 offen offset:1024 nt
    buffer_load_dwordx4 v[152:155], v4, s[32:35], s61 offen offset:2048 nt
    buffer_load_dwordx4 v[156:159], v4, s[32:35], s61 offen offset:3072 nt
    v_cndmask_b32 v32, v48, v49, s[62:63]
    v_cndmask_b32 v33, v52, v53, s[62:63]
    v_cndmask_b32 v34, v56, v57, s[62:63]
    v_cndmask_b32 v35, v60, v61, s[62:63]
    v_cndmask_b32 v32, v32, v50, s[64:65]
    v_cndmask_b32 v33, v33, v54, s[64:65]
    v_cndmask_b32 v34, v34, v58, s[64:65]
    v_cndmask_b32 v35, v35, v62, s[64:65]
    v_cndmask_b32 v32, v32, v51, s[66:67]
    v_cndmask_b32 v33, v33, v55, s[66:67]
    v_cndmask_b32 v34, v34, v59, s[66:67]
    v_cndmask_b32 v35, v35, v63, s[66:67]
    v_add_f32_dpp v32, v32, v32 quad_perm:[1,0,3,2] row_mask:0xf bank_mask:0xf
    v_add_f32_dpp v33, v33, v33 quad_perm:[1,0,3,2] row_mask:0xf bank_mask:0xf
    v_add_f32_dpp v34, v34, v34 quad_perm:[1,0,3,2] row_mask:0xf bank_mask:0xf
    v_add_f32_dpp v35, v35, v35 quad_perm:[1,0,3,2] row_mask:0xf bank_mask:0xf
    v_add_f32_dpp v32, v32, v32 quad_perm:[2,3,0,1] row_mask:0xf bank_mask:0xf
    v_add_f32_dpp v33, v33, v33 quad_perm:[2,3,0,1] row_mask:0xf bank_mask:0xf
    v_add_f32_dpp v34, v34, v34 quad_perm:[2,3,0,1] row_mask:0xf bank_mask:0xf
    v_add_f32_dpp v35, v35, v35 quad_perm:[2,3,0,1] row_mask:0xf bank_mask:0xf
    v_cndmask_b32 v26, v32, v33, s[62:63]
    v_cndmask_b32 v26, v26, v34, s[64:65]
    v_cndmask_b32 v26, v26, v35, s[66:67]
    s_waitcnt vmcnt(40)
    v_mfma_f32_16x16x32_bf16 v[48:51], v[16:19], v[160:163], 0
    v_mfma_f32_16x16x32_bf16 v[52:55], v[16:19], v[168:171], 0
    v_mfma_f32_16x16x32_bf16 v[56:59], v[16:19], v[176:179], 0
    v_mfma_f32_16x16x32_bf16 v[60:63], v[16:19], v[184:187], 0
    v_mfma_f32_16x16x32_bf16 v[48:51], v[20:23], v[164:167], v[48:51]
    v_mfma_f32_16x16x32_bf16 v[52:55], v[20:23], v[172:175], v[52:55]
    v_mfma_f32_16x16x32_bf16 v[56:59], v[20:23], v[180:183], v[56:59]
    v_mfma_f32_16x16x32_bf16 v[60:63], v[20:23], v[188:191], v[60:63]
    s_add_u32 s61, s59, 65536
    buffer_load_dwordx4 v[160:163], v3, s[32:35], s61 offen offset:0 nt
    buffer_load_dwordx4 v[164:167], v3, s[32:35], s61 offen offset:1024 nt
    buffer_load_dwordx4 v[168:171], v3, s[32:35], s61 offen offset:2048 nt
    buffer_load_dwordx4 v[172:175], v3, s[32:35], s61 offen offset:3072 nt
    buffer_load_dwordx4 v[176:179], v4, s[32:35], s61 offen offset:0 nt
    buffer_load_dwordx4 v[180:183], v4, s[32:35], s61 offen offset:1024 nt
    buffer_load_dwordx4 v[184:187], v4, s[32:35], s61 offen offset:2048 nt
    buffer_load_dwordx4 v[188:191], v4, s[32:35], s61 offen offset:3072 nt
    s_mul_i32 s73, s52, 3584
    s_lshl_b32 s74, s53, 9
    s_lshl_b32 s75, s55, 5
    s_add_u32 s74, s74, s75
    s_mul_i32 s74, s74, 896
    s_add_u32 s74, s74, s73
    s_add_u32 s75, s74, 229376
    s_mul_i32 s82, s72, 28672
    s_add_u32 s82, s82, s73
    s_mov_b32 exec_hi, 0x00ffffff
    s_add_u32 m0, s73, 0
    s_nop 0
    buffer_load_dwordx4 v3, s[40:43], s74 offen offset:0  lds
    buffer_load_dwordx4 v3, s[40:43], s74 offen offset:896  lds
    buffer_load_dwordx4 v3, s[40:43], s74 offen offset:1792  lds
    buffer_load_dwordx4 v3, s[40:43], s74 offen offset:2688  lds
    s_add_u32 m0, s73, 28672
    s_nop 0
    buffer_load_dwordx4 v3, s[40:43], s75 offen offset:0  lds
    buffer_load_dwordx4 v3, s[40:43], s75 offen offset:896  lds
    buffer_load_dwordx4 v3, s[40:43], s75 offen offset:1792  lds
    buffer_load_dwordx4 v3, s[40:43], s75 offen offset:2688  lds
    s_add_u32 m0, s73, 57344
    s_and_b64 exec, exec, s[92:93]
    buffer_load_dwordx4 v3, s[44:47], s82 offen offset:0  lds
    buffer_load_dwordx4 v3, s[44:47], s82 offen offset:896  lds
    buffer_load_dwordx4 v3, s[44:47], s82 offen offset:1792  lds
    buffer_load_dwordx4 v3, s[44:47], s82 offen offset:2688  lds
    s_mov_b64 exec, -1
    v_cndmask_b32 v32, v48, v49, s[62:63]
    v_cndmask_b32 v33, v52, v53, s[62:63]
    v_cndmask_b32 v34, v56, v57, s[62:63]
    v_cndmask_b32 v35, v60, v61, s[62:63]
    v_cndmask_b32 v32, v32, v50, s[64:65]
    v_cndmask_b32 v33, v33, v54, s[64:65]
    v_cndmask_b32 v34, v34, v58, s[64:65]
    v_cndmask_b32 v35, v35, v62, s[64:65]
    v_cndmask_b32 v32, v32, v51, s[66:67]
    v_cndmask_b32 v33, v33, v55, s[66:67]
    v_cndmask_b32 v34, v34, v59, s[66:67]
    v_cndmask_b32 v35, v35, v63, s[66:67]
    v_add_f32_dpp v32, v32, v32 quad_perm:[1,0,3,2] row_mask:0xf bank_mask:0xf
    v_add_f32_dpp v33, v33, v33 quad_perm:[1,0,3,2] row_mask:0xf bank_mask:0xf
    v_add_f32_dpp v34, v34, v34 quad_perm:[1,0,3,2] row_mask:0xf bank_mask:0xf
    v_add_f32_dpp v35, v35, v35 quad_perm:[1,0,3,2] row_mask:0xf bank_mask:0xf
    v_add_f32_dpp v32, v32, v32 quad_perm:[2,3,0,1] row_mask:0xf bank_mask:0xf
    v_add_f32_dpp v33, v33, v33 quad_perm:[2,3,0,1] row_mask:0xf bank_mask:0xf
    v_add_f32_dpp v34, v34, v34 quad_perm:[2,3,0,1] row_mask:0xf bank_mask:0xf
    v_add_f32_dpp v35, v35, v35 quad_perm:[2,3,0,1] row_mask:0xf bank_mask:0xf
    v_cndmask_b32 v27, v32, v33, s[62:63]
    v_cndmask_b32 v27, v27, v34, s[64:65]
    v_cndmask_b32 v27, v27, v35, s[66:67]
    s_setprio 2
    s_waitcnt vmcnt(52)
    v_mfma_f32_16x16x32_bf16 v[48:51], v[16:19], v[192:195], 0
    v_mfma_f32_16x16x32_bf16 v[52:55], v[16:19], v[200:203], 0
    v_mfma_f32_16x16x32_bf16 v[56:59], v[16:19], v[208:211], 0
    v_mfma_f32_16x16x32_bf16 v[60:63], v[16:19], v[216:219], 0
    v_mfma_f32_16x16x32_bf16 v[48:51], v[20:23], v[196:199], v[48:51]
    v_mfma_f32_16x16x32_bf16 v[52:55], v[20:23], v[204:207], v[52:55]
    v_mfma_f32_16x16x32_bf16 v[56:59], v[20:23], v[212:215], v[56:59]
    v_mfma_f32_16x16x32_bf16 v[60:63], v[20:23], v[220:223], v[60:63]
    s_add_u32 s61, s59, 131072
    buffer_load_dwordx4 v[192:195], v3, s[32:35], s61 offen offset:0 nt
    buffer_load_dwordx4 v[196:199], v3, s[32:35], s61 offen offset:1024 nt
    buffer_load_dwordx4 v[200:203], v3, s[32:35], s61 offen offset:2048 nt
    buffer_load_dwordx4 v[204:207], v3, s[32:35], s61 offen offset:3072 nt
    buffer_load_dwordx4 v[208:211], v4, s[32:35], s61 offen offset:0 nt
    buffer_load_dwordx4 v[212:215], v4, s[32:35], s61 offen offset:1024 nt
    buffer_load_dwordx4 v[216:219], v4, s[32:35], s61 offen offset:2048 nt
    buffer_load_dwordx4 v[220:223], v4, s[32:35], s61 offen offset:3072 nt
    v_cndmask_b32 v32, v48, v49, s[62:63]
    v_cndmask_b32 v33, v52, v53, s[62:63]
    v_cndmask_b32 v34, v56, v57, s[62:63]
    v_cndmask_b32 v35, v60, v61, s[62:63]
    v_cndmask_b32 v32, v32, v50, s[64:65]
    v_cndmask_b32 v33, v33, v54, s[64:65]
    v_cndmask_b32 v34, v34, v58, s[64:65]
    v_cndmask_b32 v35, v35, v62, s[64:65]
    v_cndmask_b32 v32, v32, v51, s[66:67]
    v_cndmask_b32 v33, v33, v55, s[66:67]
    v_cndmask_b32 v34, v34, v59, s[66:67]
    v_cndmask_b32 v35, v35, v63, s[66:67]
    v_add_f32_dpp v32, v32, v32 quad_perm:[1,0,3,2] row_mask:0xf bank_mask:0xf
    v_add_f32_dpp v33, v33, v33 quad_perm:[1,0,3,2] row_mask:0xf bank_mask:0xf
    v_add_f32_dpp v34, v34, v34 quad_perm:[1,0,3,2] row_mask:0xf bank_mask:0xf
    v_add_f32_dpp v35, v35, v35 quad_perm:[1,0,3,2] row_mask:0xf bank_mask:0xf
    v_add_f32_dpp v32, v32, v32 quad_perm:[2,3,0,1] row_mask:0xf bank_mask:0xf
    v_add_f32_dpp v33, v33, v33 quad_perm:[2,3,0,1] row_mask:0xf bank_mask:0xf
    v_add_f32_dpp v34, v34, v34 quad_perm:[2,3,0,1] row_mask:0xf bank_mask:0xf
    v_add_f32_dpp v35, v35, v35 quad_perm:[2,3,0,1] row_mask:0xf bank_mask:0xf
    v_cndmask_b32 v28, v32, v33, s[62:63]
    v_cndmask_b32 v28, v28, v34, s[64:65]
    v_cndmask_b32 v28, v28, v35, s[66:67]
    s_waitcnt vmcnt(52)
    v_mfma_f32_16x16x32_bf16 v[48:51], v[16:19], v[224:227], 0
    v_mfma_f32_16x16x32_bf16 v[52:55], v[16:19], v[232:235], 0
    v_mfma_f32_16x16x32_bf16 v[56:59], v[16:19], v[240:243], 0
    v_mfma_f32_16x16x32_bf16 v[60:63], v[16:19], v[248:251], 0
    v_mfma_f32_16x16x32_bf16 v[48:51], v[20:23], v[228:231], v[48:51]
    v_mfma_f32_16x16x32_bf16 v[52:55], v[20:23], v[236:239], v[52:55]
    v_mfma_f32_16x16x32_bf16 v[56:59], v[20:23], v[244:247], v[56:59]
    v_mfma_f32_16x16x32_bf16 v[60:63], v[20:23], v[252:255], v[60:63]
    s_add_u32 s61, s59, 196608
    buffer_load_dwordx4 v[224:227], v3, s[32:35], s61 offen offset:0 nt
    buffer_load_dwordx4 v[228:231], v3, s[32:35], s61 offen offset:1024 nt
    buffer_load_dwordx4 v[232:235], v3, s[32:35], s61 offen offset:2048 nt
    buffer_load_dwordx4 v[236:239], v3, s[32:35], s61 offen offset:3072 nt
    buffer_load_dwordx4 v[240:243], v4, s[32:35], s61 offen offset:0 nt
    buffer_load_dwordx4 v[244:247], v4, s[32:35], s61 offen offset:1024 nt
    buffer_load_dwordx4 v[248:251], v4, s[32:35], s61 offen offset:2048 nt
    buffer_load_dwordx4 v[252:255], v4, s[32:35], s61 offen offset:3072 nt
    v_cndmask_b32 v32, v48, v49, s[62:63]
    v_cndmask_b32 v33, v52, v53, s[62:63]
    v_cndmask_b32 v34, v56, v57, s[62:63]
    v_cndmask_b32 v35, v60, v61, s[62:63]
    v_cndmask_b32 v32, v32, v50, s[64:65]
    v_cndmask_b32 v33, v33, v54, s[64:65]
    v_cndmask_b32 v34, v34, v58, s[64:65]
    v_cndmask_b32 v35, v35, v62, s[64:65]
    v_cndmask_b32 v32, v32, v51, s[66:67]
    v_cndmask_b32 v33, v33, v55, s[66:67]
    v_cndmask_b32 v34, v34, v59, s[66:67]
    v_cndmask_b32 v35, v35, v63, s[66:67]
    v_add_f32_dpp v32, v32, v32 quad_perm:[1,0,3,2] row_mask:0xf bank_mask:0xf
    v_add_f32_dpp v33, v33, v33 quad_perm:[1,0,3,2] row_mask:0xf bank_mask:0xf
    v_add_f32_dpp v34, v34, v34 quad_perm:[1,0,3,2] row_mask:0xf bank_mask:0xf
    v_add_f32_dpp v35, v35, v35 quad_perm:[1,0,3,2] row_mask:0xf bank_mask:0xf
    v_add_f32_dpp v32, v32, v32 quad_perm:[2,3,0,1] row_mask:0xf bank_mask:0xf
    v_add_f32_dpp v33, v33, v33 quad_perm:[2,3,0,1] row_mask:0xf bank_mask:0xf
    v_add_f32_dpp v34, v34, v34 quad_perm:[2,3,0,1] row_mask:0xf bank_mask:0xf
    v_add_f32_dpp v35, v35, v35 quad_perm:[2,3,0,1] row_mask:0xf bank_mask:0xf
    v_cndmask_b32 v29, v32, v33, s[62:63]
    v_cndmask_b32 v29, v29, v34, s[64:65]
    v_cndmask_b32 v29, v29, v35, s[66:67]
    s_waitcnt vmcnt(52)
    v_mfma_f32_16x16x32_bf16 v[48:51], v[16:19], v[64:67], 0
    v_mfma_f32_16x16x32_bf16 v[52:55], v[16:19], v[72:75], 0
    v_mfma_f32_16x16x32_bf16 v[56:59], v[16:19], v[80:83], 0
    v_mfma_f32_16x16x32_bf16 v[60:63], v[16:19], v[88:91], 0
    v_mfma_f32_16x16x32_bf16 v[48:51], v[20:23], v[68:71], v[48:51]
    v_mfma_f32_16x16x32_bf16 v[52:55], v[20:23], v[76:79], v[52:55]
    v_mfma_f32_16x16x32_bf16 v[56:59], v[20:23], v[84:87], v[56:59]
    v_mfma_f32_16x16x32_bf16 v[60:63], v[20:23], v[92:95], v[60:63]
    s_add_u32 s61, s59, 262144
    buffer_load_dwordx4 v[64:67], v3, s[32:35], s61 offen offset:0 nt
    buffer_load_dwordx4 v[68:71], v3, s[32:35], s61 offen offset:1024 nt
    buffer_load_dwordx4 v[72:75], v3, s[32:35], s61 offen offset:2048 nt
    buffer_load_dwordx4 v[76:79], v3, s[32:35], s61 offen offset:3072 nt
    buffer_load_dwordx4 v[80:83], v4, s[32:35], s61 offen offset:0 nt
    buffer_load_dwordx4 v[84:87], v4, s[32:35], s61 offen offset:1024 nt
    buffer_load_dwordx4 v[88:91], v4, s[32:35], s61 offen offset:2048 nt
    buffer_load_dwordx4 v[92:95], v4, s[32:35], s61 offen offset:3072 nt
    v_cndmask_b32 v32, v48, v49, s[62:63]
    v_cndmask_b32 v33, v52, v53, s[62:63]
    v_cndmask_b32 v34, v56, v57, s[62:63]
    v_cndmask_b32 v35, v60, v61, s[62:63]
    v_cndmask_b32 v32, v32, v50, s[64:65]
    v_cndmask_b32 v33, v33, v54, s[64:65]
    v_cndmask_b32 v34, v34, v58, s[64:65]
    v_cndmask_b32 v35, v35, v62, s[64:65]
    v_cndmask_b32 v32, v32, v51, s[66:67]
    v_cndmask_b32 v33, v33, v55, s[66:67]
    v_cndmask_b32 v34, v34, v59, s[66:67]
    v_cndmask_b32 v35, v35, v63, s[66:67]
    v_add_f32_dpp v32, v32, v32 quad_perm:[1,0,3,2] row_mask:0xf bank_mask:0xf
    v_add_f32_dpp v33, v33, v33 quad_perm:[1,0,3,2] row_mask:0xf bank_mask:0xf
    v_add_f32_dpp v34, v34, v34 quad_perm:[1,0,3,2] row_mask:0xf bank_mask:0xf
    v_add_f32_dpp v35, v35, v35 quad_perm:[1,0,3,2] row_mask:0xf bank_mask:0xf
    v_add_f32_dpp v32, v32, v32 quad_perm:[2,3,0,1] row_mask:0xf bank_mask:0xf
    v_add_f32_dpp v33, v33, v33 quad_perm:[2,3,0,1] row_mask:0xf bank_mask:0xf
    v_add_f32_dpp v34, v34, v34 quad_perm:[2,3,0,1] row_mask:0xf bank_mask:0xf
    v_add_f32_dpp v35, v35, v35 quad_perm:[2,3,0,1] row_mask:0xf bank_mask:0xf
    v_cndmask_b32 v30, v32, v33, s[62:63]
    v_cndmask_b32 v30, v30, v34, s[64:65]
    v_cndmask_b32 v30, v30, v35, s[66:67]
    s_waitcnt vmcnt(52)
    v_mfma_f32_16x16x32_bf16 v[48:51], v[16:19], v[96:99], 0
    v_mfma_f32_16x16x32_bf16 v[52:55], v[16:19], v[104:107], 0
    v_mfma_f32_16x16x32_bf16 v[56:59], v[16:19], v[112:115], 0
    v_mfma_f32_16x16x32_bf16 v[60:63], v[16:19], v[120:123], 0
    v_mfma_f32_16x16x32_bf16 v[48:51], v[20:23], v[100:103], v[48:51]
    v_mfma_f32_16x16x32_bf16 v[52:55], v[20:23], v[108:111], v[52:55]
    v_mfma_f32_16x16x32_bf16 v[56:59], v[20:23], v[116:119], v[56:59]
    v_mfma_f32_16x16x32_bf16 v[60:63], v[20:23], v[124:127], v[60:63]
    s_add_u32 s61, s59, 327680
    buffer_load_dwordx4 v[96:99], v3, s[32:35], s61 offen offset:0 nt
    buffer_load_dwordx4 v[100:103], v3, s[32:35], s61 offen offset:1024 nt
    buffer_load_dwordx4 v[104:107], v3, s[32:35], s61 offen offset:2048 nt
    buffer_load_dwordx4 v[108:111], v3, s[32:35], s61 offen offset:3072 nt
    buffer_load_dwordx4 v[112:115], v4, s[32:35], s61 offen offset:0 nt
    buffer_load_dwordx4 v[116:119], v4, s[32:35], s61 offen offset:1024 nt
    buffer_load_dwordx4 v[120:123], v4, s[32:35], s61 offen offset:2048 nt
    buffer_load_dwordx4 v[124:127], v4, s[32:35], s61 offen offset:3072 nt
    v_cndmask_b32 v32, v48, v49, s[62:63]
    v_cndmask_b32 v33, v52, v53, s[62:63]
    v_cndmask_b32 v34, v56, v57, s[62:63]
    v_cndmask_b32 v35, v60, v61, s[62:63]
    v_cndmask_b32 v32, v32, v50, s[64:65]
    v_cndmask_b32 v33, v33, v54, s[64:65]
    v_cndmask_b32 v34, v34, v58, s[64:65]
    v_cndmask_b32 v35, v35, v62, s[64:65]
    v_cndmask_b32 v32, v32, v51, s[66:67]
    v_cndmask_b32 v33, v33, v55, s[66:67]
    v_cndmask_b32 v34, v34, v59, s[66:67]
    v_cndmask_b32 v35, v35, v63, s[66:67]
    v_add_f32_dpp v32, v32, v32 quad_perm:[1,0,3,2] row_mask:0xf bank_mask:0xf
    v_add_f32_dpp v33, v33, v33 quad_perm:[1,0,3,2] row_mask:0xf bank_mask:0xf
    v_add_f32_dpp v34, v34, v34 quad_perm:[1,0,3,2] row_mask:0xf bank_mask:0xf
    v_add_f32_dpp v35, v35, v35 quad_perm:[1,0,3,2] row_mask:0xf bank_mask:0xf
    v_add_f32_dpp v32, v32, v32 quad_perm:[2,3,0,1] row_mask:0xf bank_mask:0xf
    v_add_f32_dpp v33, v33, v33 quad_perm:[2,3,0,1] row_mask:0xf bank_mask:0xf
    v_add_f32_dpp v34, v34, v34 quad_perm:[2,3,0,1] row_mask:0xf bank_mask:0xf
    v_add_f32_dpp v35, v35, v35 quad_perm:[2,3,0,1] row_mask:0xf bank_mask:0xf
    v_cndmask_b32 v31, v32, v33, s[62:63]
    v_cndmask_b32 v31, v31, v34, s[64:65]
    v_cndmask_b32 v31, v31, v35, s[66:67]
    v_max3_f32 v32, v24, v25, v26
    v_max3_f32 v33, v27, v28, v29
    v_max3_f32 v32, v32, v30, v31
    v_max_f32 v32, v32, v33
    s_nop 1
    v_max_f32_dpp v32, v32, v32 row_ror:8 row_mask:0xf bank_mask:0xf
    s_nop 1
    v_max_f32_dpp v32, v32, v32 row_ror:4 row_mask:0xf bank_mask:0xf
    s_nop 1
    v_max_f32_dpp v32, v32, v32 row_ror:2 row_mask:0xf bank_mask:0xf
    s_nop 1
    v_max_f32_dpp v32, v32, v32 row_ror:1 row_mask:0xf bank_mask:0xf
    v_mul_f32 v36, s81, v32
    v_fma_f32 v24, v24, s81, -v36
    v_fma_f32 v25, v25, s81, -v36
    v_fma_f32 v26, v26, s81, -v36
    v_fma_f32 v27, v27, s81, -v36
    v_fma_f32 v28, v28, s81, -v36
    v_fma_f32 v29, v29, s81, -v36
    v_fma_f32 v30, v30, s81, -v36
    v_fma_f32 v31, v31, s81, -v36
    v_exp_f32 v24, v24
    v_exp_f32 v25, v25
    v_exp_f32 v26, v26
    v_exp_f32 v27, v27
    v_exp_f32 v28, v28
    v_exp_f32 v29, v29
    v_exp_f32 v30, v30
    v_exp_f32 v31, v31
    v_add_f32 v32, v24, v25
    v_add_f32 v33, v26, v27
    v_add_f32 v34, v28, v29
    v_add_f32 v35, v30, v31
    v_add_f32 v32, v32, v33
    v_add_f32 v34, v34, v35
    v_add_f32 v37, v32, v34
    v_cvt_pk_bf16_f32 v40, v24, v25
    v_cvt_pk_bf16_f32 v41, v26, v27
    v_cvt_pk_bf16_f32 v42, v28, v29
    v_cvt_pk_bf16_f32 v43, v30, v31
    v_add_f32_dpp v37, v37, v37 row_ror:8 row_mask:0xf bank_mask:0xf
    s_nop 1
    v_add_f32_dpp v37, v37, v37 row_ror:4 row_mask:0xf bank_mask:0xf
    s_nop 1
    v_add_f32_dpp v37, v37, v37 row_ror:2 row_mask:0xf bank_mask:0xf
    s_nop 1
    v_add_f32_dpp v37, v37, v37 row_ror:1 row_mask:0xf bank_mask:0xf
    ds_write_b16 v5, v40 offset:0
    ds_write_b16_d16_hi v5, v40 offset:32
    ds_write_b16 v5, v41 offset:64
    ds_write_b16_d16_hi v5, v41 offset:96
    ds_write_b16 v5, v42 offset:128
    ds_write_b16_d16_hi v5, v42 offset:160
    ds_write_b16 v5, v43 offset:192
    ds_write_b16_d16_hi v5, v43 offset:224
    s_lshl_b32 s73, s52, 3
    s_add_u32 s73, s73, 152960
    v_lshl_add_u32 v14, v0, 2, s73
    s_mov_b32 exec_lo, 0x00010001
    s_mov_b32 exec_hi, 0
    ds_write_b64 v14, v[36:37]
    s_mov_b64 exec, -1
    s_waitcnt lgkmcnt(0)
    ds_read_b128 v[12:15], v6
    s_setprio 1
    s_waitcnt vmcnt(52)
    s_waitcnt lgkmcnt(0)
    v_perm_b32 v48, v132, v128, s68
    v_perm_b32 v49, v140, v136, s68
    v_perm_b32 v50, v148, v144, s68
    v_perm_b32 v51, v156, v152, s68
    v_perm_b32 v52, v132, v128, s69
    v_perm_b32 v53, v140, v136, s69
    v_perm_b32 v54, v148, v144, s69
    v_perm_b32 v55, v156, v152, s69
    v_perm_b32 v56, v133, v129, s68
    v_perm_b32 v57, v141, v137, s68
    v_perm_b32 v58, v149, v145, s68
    v_perm_b32 v59, v157, v153, s68
    v_perm_b32 v60, v133, v129, s69
    v_perm_b32 v61, v141, v137, s69
    v_perm_b32 v62, v149, v145, s69
    v_perm_b32 v63, v157, v153, s69
    v_mfma_f32_16x16x32_bf16 v[16:19], v[12:15], v[48:51], 0
    v_mfma_f32_16x16x32_bf16 v[20:23], v[12:15], v[52:55], 0
    v_mfma_f32_16x16x32_bf16 v[24:27], v[12:15], v[56:59], 0
    v_mfma_f32_16x16x32_bf16 v[28:31], v[12:15], v[60:63], 0
    v_perm_b32 v48, v134, v130, s68
    v_perm_b32 v49, v142, v138, s68
    v_perm_b32 v50, v150, v146, s68
    v_perm_b32 v51, v158, v154, s68
    v_perm_b32 v52, v134, v130, s69
    v_perm_b32 v53, v142, v138, s69
    v_perm_b32 v54, v150, v146, s69
    v_perm_b32 v55, v158, v154, s69
    v_perm_b32 v56, v135, v131, s68
    v_perm_b32 v57, v143, v139, s68
    v_perm_b32 v58, v151, v147, s68
    v_perm_b32 v59, v159, v155, s68
    v_perm_b32 v60, v135, v131, s69
    v_perm_b32 v61, v143, v139, s69
    v_perm_b32 v62, v151, v147, s69
    v_perm_b32 v63, v159, v155, s69
    s_add_u32 s61, s59, 393216
    buffer_load_dwordx4 v[128:131], v3, s[32:35], s61 offen offset:0 nt
    buffer_load_dwordx4 v[132:135], v3, s[32:35], s61 offen offset:1024 nt
    buffer_load_dwordx4 v[136:139], v3, s[32:35], s61 offen offset:2048 nt
    buffer_load_dwordx4 v[140:143], v3, s[32:35], s61 offen offset:3072 nt
    buffer_load_dwordx4 v[144:147], v4, s[32:35], s61 offen offset:0 nt
    buffer_load_dwordx4 v[148:151], v4, s[32:35], s61 offen offset:1024 nt
    buffer_load_dwordx4 v[152:155], v4, s[32:35], s61 offen offset:2048 nt
    buffer_load_dwordx4 v[156:159], v4, s[32:35], s61 offen offset:3072 nt
    v_mfma_f32_16x16x32_bf16 v[32:35], v[12:15], v[48:51], 0
    v_mfma_f32_16x16x32_bf16 v[36:39], v[12:15], v[52:55], 0
    v_mfma_f32_16x16x32_bf16 v[40:43], v[12:15], v[56:59], 0
    v_mfma_f32_16x16x32_bf16 v[44:47], v[12:15], v[60:63], 0
    ds_read_b128 v[12:15], v6 offset:32
    s_waitcnt vmcnt(52)
    s_waitcnt lgkmcnt(0)
    v_perm_b32 v48, v164, v160, s68
    v_perm_b32 v49, v172, v168, s68
    v_perm_b32 v50, v180, v176, s68
    v_perm_b32 v51, v188, v184, s68
    v_perm_b32 v52, v164, v160, s69
    v_perm_b32 v53, v172, v168, s69
    v_perm_b32 v54, v180, v176, s69
    v_perm_b32 v55, v188, v184, s69
    v_perm_b32 v56, v165, v161, s68
    v_perm_b32 v57, v173, v169, s68
    v_perm_b32 v58, v181, v177, s68
    v_perm_b32 v59, v189, v185, s68
    v_perm_b32 v60, v165, v161, s69
    v_perm_b32 v61, v173, v169, s69
    v_perm_b32 v62, v181, v177, s69
    v_perm_b32 v63, v189, v185, s69
    v_mfma_f32_16x16x32_bf16 v[16:19], v[12:15], v[48:51], v[16:19]
    v_mfma_f32_16x16x32_bf16 v[20:23], v[12:15], v[52:55], v[20:23]
    v_mfma_f32_16x16x32_bf16 v[24:27], v[12:15], v[56:59], v[24:27]
    v_mfma_f32_16x16x32_bf16 v[28:31], v[12:15], v[60:63], v[28:31]
    v_perm_b32 v48, v166, v162, s68
    v_perm_b32 v49, v174, v170, s68
    v_perm_b32 v50, v182, v178, s68
    v_perm_b32 v51, v190, v186, s68
    v_perm_b32 v52, v166, v162, s69
    v_perm_b32 v53, v174, v170, s69
    v_perm_b32 v54, v182, v178, s69
    v_perm_b32 v55, v190, v186, s69
    v_perm_b32 v56, v167, v163, s68
    v_perm_b32 v57, v175, v171, s68
    v_perm_b32 v58, v183, v179, s68
    v_perm_b32 v59, v191, v187, s68
    v_perm_b32 v60, v167, v163, s69
    v_perm_b32 v61, v175, v171, s69
    v_perm_b32 v62, v183, v179, s69
    v_perm_b32 v63, v191, v187, s69
    s_add_u32 s61, s59, 458752
    buffer_load_dwordx4 v[160:163], v3, s[32:35], s61 offen offset:0 nt
    buffer_load_dwordx4 v[164:167], v3, s[32:35], s61 offen offset:1024 nt
    buffer_load_dwordx4 v[168:171], v3, s[32:35], s61 offen offset:2048 nt
    buffer_load_dwordx4 v[172:175], v3, s[32:35], s61 offen offset:3072 nt
    buffer_load_dwordx4 v[176:179], v4, s[32:35], s61 offen offset:0 nt
    buffer_load_dwordx4 v[180:183], v4, s[32:35], s61 offen offset:1024 nt
    buffer_load_dwordx4 v[184:187], v4, s[32:35], s61 offen offset:2048 nt
    buffer_load_dwordx4 v[188:191], v4, s[32:35], s61 offen offset:3072 nt
    v_mfma_f32_16x16x32_bf16 v[32:35], v[12:15], v[48:51], v[32:35]
    v_mfma_f32_16x16x32_bf16 v[36:39], v[12:15], v[52:55], v[36:39]
    v_mfma_f32_16x16x32_bf16 v[40:43], v[12:15], v[56:59], v[40:43]
    v_mfma_f32_16x16x32_bf16 v[44:47], v[12:15], v[60:63], v[44:47]
    ds_read_b128 v[12:15], v6 offset:64
    s_waitcnt vmcnt(40)
    s_waitcnt lgkmcnt(0)
    v_perm_b32 v48, v196, v192, s68
    v_perm_b32 v49, v204, v200, s68
    v_perm_b32 v50, v212, v208, s68
    v_perm_b32 v51, v220, v216, s68
    v_perm_b32 v52, v196, v192, s69
    v_perm_b32 v53, v204, v200, s69
    v_perm_b32 v54, v212, v208, s69
    v_perm_b32 v55, v220, v216, s69
    v_perm_b32 v56, v197, v193, s68
    v_perm_b32 v57, v205, v201, s68
    v_perm_b32 v58, v213, v209, s68
    v_perm_b32 v59, v221, v217, s68
    v_perm_b32 v60, v197, v193, s69
    v_perm_b32 v61, v205, v201, s69
    v_perm_b32 v62, v213, v209, s69
    v_perm_b32 v63, v221, v217, s69
    v_mfma_f32_16x16x32_bf16 v[16:19], v[12:15], v[48:51], v[16:19]
    v_mfma_f32_16x16x32_bf16 v[20:23], v[12:15], v[52:55], v[20:23]
    v_mfma_f32_16x16x32_bf16 v[24:27], v[12:15], v[56:59], v[24:27]
    v_mfma_f32_16x16x32_bf16 v[28:31], v[12:15], v[60:63], v[28:31]
    v_perm_b32 v48, v198, v194, s68
    v_perm_b32 v49, v206, v202, s68
    v_perm_b32 v50, v214, v210, s68
    v_perm_b32 v51, v222, v218, s68
    v_perm_b32 v52, v198, v194, s69
    v_perm_b32 v53, v206, v202, s69
    v_perm_b32 v54, v214, v210, s69
    v_perm_b32 v55, v222, v218, s69
    v_perm_b32 v56, v199, v195, s68
    v_perm_b32 v57, v207, v203, s68
    v_perm_b32 v58, v215, v211, s68
    v_perm_b32 v59, v223, v219, s68
    v_perm_b32 v60, v199, v195, s69
    v_perm_b32 v61, v207, v203, s69
    v_perm_b32 v62, v215, v211, s69
    v_perm_b32 v63, v223, v219, s69
    v_mfma_f32_16x16x32_bf16 v[32:35], v[12:15], v[48:51], v[32:35]
    v_mfma_f32_16x16x32_bf16 v[36:39], v[12:15], v[52:55], v[36:39]
    v_mfma_f32_16x16x32_bf16 v[40:43], v[12:15], v[56:59], v[40:43]
    v_mfma_f32_16x16x32_bf16 v[44:47], v[12:15], v[60:63], v[44:47]
    ds_read_b128 v[12:15], v6 offset:96
    s_waitcnt vmcnt(32)
    s_waitcnt lgkmcnt(0)
    v_perm_b32 v48, v228, v224, s68
    v_perm_b32 v49, v236, v232, s68
    v_perm_b32 v50, v244, v240, s68
    v_perm_b32 v51, v252, v248, s68
    v_perm_b32 v52, v228, v224, s69
    v_perm_b32 v53, v236, v232, s69
    v_perm_b32 v54, v244, v240, s69
    v_perm_b32 v55, v252, v248, s69
    v_perm_b32 v56, v229, v225, s68
    v_perm_b32 v57, v237, v233, s68
    v_perm_b32 v58, v245, v241, s68
    v_perm_b32 v59, v253, v249, s68
    v_perm_b32 v60, v229, v225, s69
    v_perm_b32 v61, v237, v233, s69
    v_perm_b32 v62, v245, v241, s69
    v_perm_b32 v63, v253, v249, s69
    v_mfma_f32_16x16x32_bf16 v[16:19], v[12:15], v[48:51], v[16:19]
    v_mfma_f32_16x16x32_bf16 v[20:23], v[12:15], v[52:55], v[20:23]
    v_mfma_f32_16x16x32_bf16 v[24:27], v[12:15], v[56:59], v[24:27]
    v_mfma_f32_16x16x32_bf16 v[28:31], v[12:15], v[60:63], v[28:31]
    v_perm_b32 v48, v230, v226, s68
    v_perm_b32 v49, v238, v234, s68
    v_perm_b32 v50, v246, v242, s68
    v_perm_b32 v51, v254, v250, s68
    v_perm_b32 v52, v230, v226, s69
    v_perm_b32 v53, v238, v234, s69
    v_perm_b32 v54, v246, v242, s69
    v_perm_b32 v55, v254, v250, s69
    v_perm_b32 v56, v231, v227, s68
    v_perm_b32 v57, v239, v235, s68
    v_perm_b32 v58, v247, v243, s68
    v_perm_b32 v59, v255, v251, s68
    v_perm_b32 v60, v231, v227, s69
    v_perm_b32 v61, v239, v235, s69
    v_perm_b32 v62, v247, v243, s69
    v_perm_b32 v63, v255, v251, s69
    v_mfma_f32_16x16x32_bf16 v[32:35], v[12:15], v[48:51], v[32:35]
    v_mfma_f32_16x16x32_bf16 v[36:39], v[12:15], v[52:55], v[36:39]
    v_mfma_f32_16x16x32_bf16 v[40:43], v[12:15], v[56:59], v[40:43]
    v_mfma_f32_16x16x32_bf16 v[44:47], v[12:15], v[60:63], v[44:47]
    ds_read_b128 v[12:15], v6 offset:128
    s_setprio 0
    s_waitcnt vmcnt(24)
    s_waitcnt lgkmcnt(0)
    v_perm_b32 v48, v68, v64, s68
    v_perm_b32 v49, v76, v72, s68
    v_perm_b32 v50, v84, v80, s68
    v_perm_b32 v51, v92, v88, s68
    v_perm_b32 v52, v68, v64, s69
    v_perm_b32 v53, v76, v72, s69
    v_perm_b32 v54, v84, v80, s69
    v_perm_b32 v55, v92, v88, s69
    v_perm_b32 v56, v69, v65, s68
    v_perm_b32 v57, v77, v73, s68
    v_perm_b32 v58, v85, v81, s68
    v_perm_b32 v59, v93, v89, s68
    v_perm_b32 v60, v69, v65, s69
    v_perm_b32 v61, v77, v73, s69
    v_perm_b32 v62, v85, v81, s69
    v_perm_b32 v63, v93, v89, s69
    v_mfma_f32_16x16x32_bf16 v[16:19], v[12:15], v[48:51], v[16:19]
    v_mfma_f32_16x16x32_bf16 v[20:23], v[12:15], v[52:55], v[20:23]
    v_mfma_f32_16x16x32_bf16 v[24:27], v[12:15], v[56:59], v[24:27]
    v_mfma_f32_16x16x32_bf16 v[28:31], v[12:15], v[60:63], v[28:31]
    v_perm_b32 v48, v70, v66, s68
    v_perm_b32 v49, v78, v74, s68
    v_perm_b32 v50, v86, v82, s68
    v_perm_b32 v51, v94, v90, s68
    v_perm_b32 v52, v70, v66, s69
    v_perm_b32 v53, v78, v74, s69
    v_perm_b32 v54, v86, v82, s69
    v_perm_b32 v55, v94, v90, s69
    v_perm_b32 v56, v71, v67, s68
    v_perm_b32 v57, v79, v75, s68
    v_perm_b32 v58, v87, v83, s68
    v_perm_b32 v59, v95, v91, s68
    v_perm_b32 v60, v71, v67, s69
    v_perm_b32 v61, v79, v75, s69
    v_perm_b32 v62, v87, v83, s69
    v_perm_b32 v63, v95, v91, s69
    v_mfma_f32_16x16x32_bf16 v[32:35], v[12:15], v[48:51], v[32:35]
    v_mfma_f32_16x16x32_bf16 v[36:39], v[12:15], v[52:55], v[36:39]
    v_mfma_f32_16x16x32_bf16 v[40:43], v[12:15], v[56:59], v[40:43]
    v_mfma_f32_16x16x32_bf16 v[44:47], v[12:15], v[60:63], v[44:47]
    ds_read_b128 v[12:15], v6 offset:160
    s_waitcnt vmcnt(16)
    s_waitcnt lgkmcnt(0)
    v_perm_b32 v48, v100, v96, s68
    v_perm_b32 v49, v108, v104, s68
    v_perm_b32 v50, v116, v112, s68
    v_perm_b32 v51, v124, v120, s68
    v_perm_b32 v52, v100, v96, s69
    v_perm_b32 v53, v108, v104, s69
    v_perm_b32 v54, v116, v112, s69
    v_perm_b32 v55, v124, v120, s69
    v_perm_b32 v56, v101, v97, s68
    v_perm_b32 v57, v109, v105, s68
    v_perm_b32 v58, v117, v113, s68
    v_perm_b32 v59, v125, v121, s68
    v_perm_b32 v60, v101, v97, s69
    v_perm_b32 v61, v109, v105, s69
    v_perm_b32 v62, v117, v113, s69
    v_perm_b32 v63, v125, v121, s69
    v_mfma_f32_16x16x32_bf16 v[16:19], v[12:15], v[48:51], v[16:19]
    v_mfma_f32_16x16x32_bf16 v[20:23], v[12:15], v[52:55], v[20:23]
    v_mfma_f32_16x16x32_bf16 v[24:27], v[12:15], v[56:59], v[24:27]
    v_mfma_f32_16x16x32_bf16 v[28:31], v[12:15], v[60:63], v[28:31]
    v_perm_b32 v48, v102, v98, s68
    v_perm_b32 v49, v110, v106, s68
    v_perm_b32 v50, v118, v114, s68
    v_perm_b32 v51, v126, v122, s68
    v_perm_b32 v52, v102, v98, s69
    v_perm_b32 v53, v110, v106, s69
    v_perm_b32 v54, v118, v114, s69
    v_perm_b32 v55, v126, v122, s69
    v_perm_b32 v56, v103, v99, s68
    v_perm_b32 v57, v111, v107, s68
    v_perm_b32 v58, v119, v115, s68
    v_perm_b32 v59, v127, v123, s68
    v_perm_b32 v60, v103, v99, s69
    v_perm_b32 v61, v111, v107, s69
    v_perm_b32 v62, v119, v115, s69
    v_perm_b32 v63, v127, v123, s69
    v_mfma_f32_16x16x32_bf16 v[32:35], v[12:15], v[48:51], v[32:35]
    v_mfma_f32_16x16x32_bf16 v[36:39], v[12:15], v[52:55], v[36:39]
    v_mfma_f32_16x16x32_bf16 v[40:43], v[12:15], v[56:59], v[40:43]
    v_mfma_f32_16x16x32_bf16 v[44:47], v[12:15], v[60:63], v[44:47]
    ds_read_b128 v[12:15], v6 offset:192
    s_waitcnt vmcnt(8)
    s_waitcnt lgkmcnt(0)
    v_perm_b32 v48, v132, v128, s68
    v_perm_b32 v49, v140, v136, s68
    v_perm_b32 v50, v148, v144, s68
    v_perm_b32 v51, v156, v152, s68
    v_perm_b32 v52, v132, v128, s69
    v_perm_b32 v53, v140, v136, s69
    v_perm_b32 v54, v148, v144, s69
    v_perm_b32 v55, v156, v152, s69
    v_perm_b32 v56, v133, v129, s68
    v_perm_b32 v57, v141, v137, s68
    v_perm_b32 v58, v149, v145, s68
    v_perm_b32 v59, v157, v153, s68
    v_perm_b32 v60, v133, v129, s69
    v_perm_b32 v61, v141, v137, s69
    v_perm_b32 v62, v149, v145, s69
    v_perm_b32 v63, v157, v153, s69
    v_mfma_f32_16x16x32_bf16 v[16:19], v[12:15], v[48:51], v[16:19]
    v_mfma_f32_16x16x32_bf16 v[20:23], v[12:15], v[52:55], v[20:23]
    v_mfma_f32_16x16x32_bf16 v[24:27], v[12:15], v[56:59], v[24:27]
    v_mfma_f32_16x16x32_bf16 v[28:31], v[12:15], v[60:63], v[28:31]
    v_perm_b32 v48, v134, v130, s68
    v_perm_b32 v49, v142, v138, s68
    v_perm_b32 v50, v150, v146, s68
    v_perm_b32 v51, v158, v154, s68
    v_perm_b32 v52, v134, v130, s69
    v_perm_b32 v53, v142, v138, s69
    v_perm_b32 v54, v150, v146, s69
    v_perm_b32 v55, v158, v154, s69
    v_perm_b32 v56, v135, v131, s68
    v_perm_b32 v57, v143, v139, s68
    v_perm_b32 v58, v151, v147, s68
    v_perm_b32 v59, v159, v155, s68
    v_perm_b32 v60, v135, v131, s69
    v_perm_b32 v61, v143, v139, s69
    v_perm_b32 v62, v151, v147, s69
    v_perm_b32 v63, v159, v155, s69
    v_mfma_f32_16x16x32_bf16 v[32:35], v[12:15], v[48:51], v[32:35]
    v_mfma_f32_16x16x32_bf16 v[36:39], v[12:15], v[52:55], v[36:39]
    v_mfma_f32_16x16x32_bf16 v[40:43], v[12:15], v[56:59], v[40:43]
    v_mfma_f32_16x16x32_bf16 v[44:47], v[12:15], v[60:63], v[44:47]
    ds_read_b128 v[12:15], v6 offset:224
    s_waitcnt vmcnt(0)
    s_waitcnt lgkmcnt(0)
    v_perm_b32 v48, v164, v160, s68
    v_perm_b32 v49, v172, v168, s68
    v_perm_b32 v50, v180, v176, s68
    v_perm_b32 v51, v188, v184, s68
    v_perm_b32 v52, v164, v160, s69
    v_perm_b32 v53, v172, v168, s69
    v_perm_b32 v54, v180, v176, s69
    v_perm_b32 v55, v188, v184, s69
    v_perm_b32 v56, v165, v161, s68
    v_perm_b32 v57, v173, v169, s68
    v_perm_b32 v58, v181, v177, s68
    v_perm_b32 v59, v189, v185, s68
    v_perm_b32 v60, v165, v161, s69
    v_perm_b32 v61, v173, v169, s69
    v_perm_b32 v62, v181, v177, s69
    v_perm_b32 v63, v189, v185, s69
    v_mfma_f32_16x16x32_bf16 v[16:19], v[12:15], v[48:51], v[16:19]
    v_mfma_f32_16x16x32_bf16 v[20:23], v[12:15], v[52:55], v[20:23]
    v_mfma_f32_16x16x32_bf16 v[24:27], v[12:15], v[56:59], v[24:27]
    v_mfma_f32_16x16x32_bf16 v[28:31], v[12:15], v[60:63], v[28:31]
    v_perm_b32 v48, v166, v162, s68
    v_perm_b32 v49, v174, v170, s68
    v_perm_b32 v50, v182, v178, s68
    v_perm_b32 v51, v190, v186, s68
    v_perm_b32 v52, v166, v162, s69
    v_perm_b32 v53, v174, v170, s69
    v_perm_b32 v54, v182, v178, s69
    v_perm_b32 v55, v190, v186, s69
    v_perm_b32 v56, v167, v163, s68
    v_perm_b32 v57, v175, v171, s68
    v_perm_b32 v58, v183, v179, s68
    v_perm_b32 v59, v191, v187, s68
    v_perm_b32 v60, v167, v163, s69
    v_perm_b32 v61, v175, v171, s69
    v_perm_b32 v62, v183, v179, s69
    v_perm_b32 v63, v191, v187, s69
    v_mfma_f32_16x16x32_bf16 v[32:35], v[12:15], v[48:51], v[32:35]
    v_mfma_f32_16x16x32_bf16 v[36:39], v[12:15], v[52:55], v[36:39]
    v_mfma_f32_16x16x32_bf16 v[40:43], v[12:15], v[56:59], v[40:43]
    v_mfma_f32_16x16x32_bf16 v[44:47], v[12:15], v[60:63], v[44:47]
    s_lshl_b32 s73, s52, 11
    s_add_u32 s73, s73, 129024
    v_lshlrev_b32 v14, 5, v0
    v_add_u32 v14, s73, v14
    v_mov_b32 v48, v16
    v_mov_b32 v49, v20
    v_mov_b32 v50, v24
    v_mov_b32 v51, v28
    v_mov_b32 v52, v32
    v_mov_b32 v53, v36
    v_mov_b32 v54, v40
    v_mov_b32 v55, v44
    ds_write_b128 v14, v[48:51]
    ds_write_b128 v14, v[52:55] offset:16
    s_waitcnt vmcnt(0) lgkmcnt(0)
    s_barrier
    s_cmp_eq_u32 s52, 7
    s_cbranch_scc1 L_w7tail
    s_cmp_ge_u32 s52, 4
    s_cbranch_scc1 L_proj
    s_lshl_b32 s73, s52, 9
    s_add_u32 s73, s73, 129024
    v_lshl_add_u32 v14, v0, 3, s73
    s_lshr_b32 s74, s52, 1
    s_lshl_b32 s75, s74, 6
    s_add_u32 s75, s75, 152960
    v_mov_b32 v15, s75
    ds_read_b128 v[64:67], v15
    ds_read_b128 v[68:71], v15 offset:16
    ds_read_b128 v[72:75], v15 offset:32
    ds_read_b128 v[76:79], v15 offset:48
    ds_read_b64 v[24:25], v14 offset:0
    ds_read_b64 v[26:27], v14 offset:2048
    ds_read_b64 v[28:29], v14 offset:4096
    ds_read_b64 v[30:31], v14 offset:6144
    ds_read_b64 v[32:33], v14 offset:8192
    ds_read_b64 v[34:35], v14 offset:10240
    ds_read_b64 v[36:37], v14 offset:12288
    ds_read_b64 v[38:39], v14 offset:14336
    s_and_b32 s75, s52, 1
    s_lshl_b32 s75, s75, 14
    v_lshlrev_b32 v14, 12, v11
    v_lshl_add_u32 v14, v10, 4, v14
    s_lshl_b32 s73, s57, 15
    s_add_u32 s73, s73, s75
    s_lshl_b32 s75, s55, 9
    s_add_u32 s73, s73, s75
    s_lshl_b32 s75, s74, 8
    s_add_u32 s73, s73, s75
    s_add_u32 s73, s73, 262144
    v_mov_b32 v42, v8
    v_mov_b32 v43, v9
    v_mov_b32 v46, v8
    v_mov_b32 v47, v9
    s_lshl_b32 s82, s57, 11
    s_lshl_b32 s75, s55, 5
    s_add_u32 s82, s82, s75
    s_lshl_b32 s75, s74, 4
    s_add_u32 s82, s82, s75
    s_add_u32 s82, s82, 131072
    v_lshlrev_b32 v15, 8, v0
    s_waitcnt lgkmcnt(8)
    v_max3_f32 v44, v64, v66, v68
    v_max3_f32 v45, v70, v72, v74
    v_max3_f32 v44, v44, v76, v78
    v_max_f32 v44, v44, v45
    v_sub_f32 v16, v64, v44
    v_sub_f32 v17, v66, v44
    v_sub_f32 v18, v68, v44
    v_sub_f32 v19, v70, v44
    v_sub_f32 v20, v72, v44
    v_sub_f32 v21, v74, v44
    v_sub_f32 v22, v76, v44
    v_sub_f32 v23, v78, v44
    v_exp_f32 v16, v16
    v_exp_f32 v17, v17
    v_exp_f32 v18, v18
    v_exp_f32 v19, v19
    v_exp_f32 v20, v20
    v_exp_f32 v21, v21
    v_exp_f32 v22, v22
    v_exp_f32 v23, v23
    s_waitcnt lgkmcnt(0)
    v_mul_f32 v40, v16, v24
    v_mul_f32 v41, v16, v25
    v_mul_f32 v45, v16, v65
    v_fmac_f32 v40, v17, v26
    v_fmac_f32 v41, v17, v27
    v_fmac_f32 v45, v17, v67
    v_fmac_f32 v40, v18, v28
    v_fmac_f32 v41, v18, v29
    v_fmac_f32 v45, v18, v69
    v_fmac_f32 v40, v19, v30
    v_fmac_f32 v41, v19, v31
    v_fmac_f32 v45, v19, v71
    v_fmac_f32 v40, v20, v32
    v_fmac_f32 v41, v20, v33
    v_fmac_f32 v45, v20, v73
    v_fmac_f32 v40, v21, v34
    v_fmac_f32 v41, v21, v35
    v_fmac_f32 v45, v21, v75
    v_fmac_f32 v40, v22, v36
    v_fmac_f32 v41, v22, v37
    v_fmac_f32 v45, v22, v77
    v_fmac_f32 v40, v23, v38
    v_fmac_f32 v41, v23, v39
    v_fmac_f32 v45, v23, v79
    s_cmp_eq_u32 s85, 2
    s_nop 0
    s_cbranch_scc1 L_h1loc
    buffer_store_dwordx4 v[40:43], v14, s[36:39], s73 offen sc1
    s_mov_b64 exec, 0xff
    buffer_store_dwordx4 v[44:47], v15, s[36:39], s82 offen sc1
    s_mov_b64 exec, -1
    s_nop 0
    s_branch L_h1done
L_h1loc:
    buffer_store_dwordx4 v[40:43], v14, s[36:39], s73 offen
    s_mov_b64 exec, 0xff
    buffer_store_dwordx4 v[44:47], v15, s[36:39], s82 offen
    s_mov_b64 exec, -1
    s_nop 0
L_h1done:
L_proj:
    v_lshrrev_b32 v12, 2, v10
    v_and_b32 v13, 3, v10
    v_lshl_add_u32 v14, v11, 3, v12
    v_mul_u32_u24 v14, 896, v14
    v_lshl_add_u32 v14, v13, 3, v14
    s_lshl_b32 s73, s52, 7
    v_add_u32 v14, s73, v14
    v_lshlrev_b32 v15, 4, v11
    v_add_u32 v15, 152576, v15
    ds_read_b128 v[120:123], v15 offset:128
    ds_read_b64_tr_b16 v[96:97], v14 offset:57344
    ds_read_b64_tr_b16 v[98:99], v14 offset:60928
    ds_read_b64_tr_b16 v[100:101], v14 offset:57376
    ds_read_b64_tr_b16 v[102:103], v14 offset:60960
    ds_read_b64_tr_b16 v[104:105], v14 offset:57408
    ds_read_b64_tr_b16 v[106:107], v14 offset:60992
    ds_read_b64_tr_b16 v[108:109], v14 offset:57440
    ds_read_b64_tr_b16 v[110:111], v14 offset:61024
    s_waitcnt lgkmcnt(0)
    ds_read_b64_tr_b16 v[64:65], v14 offset:0
    ds_read_b64_tr_b16 v[66:67], v14 offset:3584
    ds_read_b64_tr_b16 v[68:69], v14 offset:32
    ds_read_b64_tr_b16 v[70:71], v14 offset:3616
    ds_read_b64_tr_b16 v[72:73], v14 offset:64
    ds_read_b64_tr_b16 v[74:75], v14 offset:3648
    ds_read_b64_tr_b16 v[76:77], v14 offset:96
    ds_read_b64_tr_b16 v[78:79], v14 offset:3680
    s_waitcnt lgkmcnt(0)
    ds_read_b64_tr_b16 v[80:81], v14 offset:28672
    ds_read_b64_tr_b16 v[82:83], v14 offset:32256
    ds_read_b64_tr_b16 v[84:85], v14 offset:28704
    ds_read_b64_tr_b16 v[86:87], v14 offset:32288
    ds_read_b64_tr_b16 v[88:89], v14 offset:28736
    ds_read_b64_tr_b16 v[90:91], v14 offset:32320
    ds_read_b64_tr_b16 v[92:93], v14 offset:28768
    ds_read_b64_tr_b16 v[94:95], v14 offset:32352
    s_waitcnt lgkmcnt(0)
    v_mov_b32 v128, 0
    v_mov_b32 v129, 0
    v_mov_b32 v130, 0
    v_mov_b32 v131, 0
    v_mov_b32 v132, 0
    v_mov_b32 v133, 0
    v_mov_b32 v134, 0
    v_mov_b32 v135, 0
    v_mov_b32 v136, 0
    v_mov_b32 v137, 0
    v_mov_b32 v138, 0
    v_mov_b32 v139, 0
    v_mov_b32 v140, 0
    v_mov_b32 v141, 0
    v_mov_b32 v142, 0
    v_mov_b32 v143, 0
    s_cmp_ge_u32 s91, 56
    s_nop 0
    s_cbranch_scc1 L_noffn
    v_mfma_f32_16x16x32_bf16 v[128:131], v[96:99], v[120:123], 0
    v_mfma_f32_16x16x32_bf16 v[132:135], v[100:103], v[120:123], 0
    v_mfma_f32_16x16x32_bf16 v[136:139], v[104:107], v[120:123], 0
    v_mfma_f32_16x16x32_bf16 v[140:143], v[108:111], v[120:123], 0
    s_nop 7
L_noffn:
    v_lshrrev_b32 v12, 1, v11
    v_lshlrev_b32 v12, 12, v12
    v_and_b32 v13, 1, v11
    v_lshl_add_u32 v12, v13, 5, v12
    v_lshl_add_u32 v12, v10, 4, v12
    s_mul_i32 s73, s54, 229376
    s_lshl_b32 s74, s58, 6
    s_add_u32 s73, s73, s74
    s_lshl_b32 s74, s52, 15
    s_add_u32 s73, s73, s74
    s_add_u32 s73, s73, 1310720
    s_mov_b32 s76, 0x00020002
    s_mov_b32 s77, 0x00020002
    v_mov_b32 v146, v8
    v_mov_b32 v147, v9
    v_mov_b32 v150, v8
    v_mov_b32 v151, v9
    v_mov_b32 v154, v8
    v_mov_b32 v155, v9
    v_mov_b32 v158, v8
    v_mov_b32 v159, v9
    s_barrier
    ds_read_b128 v[112:115], v15
    ds_read_b128 v[116:119], v15 offset:64
    s_waitcnt lgkmcnt(0)
    v_mfma_f32_16x16x32_bf16 v[128:131], v[64:67], v[112:115], v[128:131]
    v_mfma_f32_16x16x32_bf16 v[132:135], v[68:71], v[112:115], v[132:135]
    v_mfma_f32_16x16x32_bf16 v[136:139], v[72:75], v[112:115], v[136:139]
    v_mfma_f32_16x16x32_bf16 v[140:143], v[76:79], v[112:115], v[140:143]
    v_mfma_f32_16x16x32_bf16 v[128:131], v[80:83], v[116:119], v[128:131]
    v_mfma_f32_16x16x32_bf16 v[132:135], v[84:87], v[116:119], v[132:135]
    v_mfma_f32_16x16x32_bf16 v[136:139], v[88:91], v[116:119], v[136:139]
    v_mfma_f32_16x16x32_bf16 v[140:143], v[92:95], v[116:119], v[140:143]
    s_nop 4
    v_cndmask_b32 v144, v128, v130, s[76:77]
    v_cndmask_b32 v145, v129, v131, s[76:77]
    v_cndmask_b32 v148, v132, v134, s[76:77]
    v_cndmask_b32 v149, v133, v135, s[76:77]
    v_cndmask_b32 v152, v136, v138, s[76:77]
    v_cndmask_b32 v153, v137, v139, s[76:77]
    v_cndmask_b32 v156, v140, v142, s[76:77]
    v_cndmask_b32 v157, v141, v143, s[76:77]
    s_mov_b32 exec_lo, 0x00030003
    s_mov_b32 exec_hi, 0x00030003
    s_add_u32 s74, s73, 0
    buffer_store_dwordx4 v[144:147], v12, s[36:39], s74 offen sc1
    s_add_u32 s74, s73, 8192
    buffer_store_dwordx4 v[148:151], v12, s[36:39], s74 offen sc1
    s_add_u32 s74, s73, 16384
    buffer_store_dwordx4 v[152:155], v12, s[36:39], s74 offen sc1
    s_add_u32 s74, s73, 24576
    buffer_store_dwordx4 v[156:159], v12, s[36:39], s74 offen sc1
    s_nop 1
    s_branch L_end
L_w7tail:
    s_lshl_b32 s73, s57, 3
    s_add_u32 s73, s73, s55
    s_lshl_b32 s82, s73, 8
    s_add_u32 s82, s82, 131072
    s_lshl_b32 s73, s73, 12
    s_add_u32 s73, s73, 262144
    v_mov_b32 v15, 152904
    ds_read_b32 v40, v15
    v_and_b32 v14, 31, v0
    v_lshlrev_b32 v14, 2, v14
    v_add_u32 v14, 152576, v14
    v_lshlrev_b32 v13, 4, v11
    s_mov_b32 s80, 0
    s_mov_b32 s80, 0
L_h1:
    buffer_load_dwordx4 v[128:131], v3, s[36:39], s73 offen offset:0 sc1
    buffer_load_dwordx4 v[132:135], v3, s[36:39], s73 offen offset:1024 sc1
    buffer_load_dwordx4 v[136:139], v3, s[36:39], s73 offen offset:2048 sc1
    buffer_load_dwordx4 v[140:143], v3, s[36:39], s73 offen offset:3072 sc1
    buffer_load_dwordx4 v[144:147], v13, s[36:39], s82 offen offset:0 sc1
    buffer_load_dwordx4 v[148:151], v13, s[36:39], s82 offen offset:64 sc1
    buffer_load_dwordx4 v[152:155], v13, s[36:39], s82 offen offset:128 sc1
    buffer_load_dwordx4 v[156:159], v13, s[36:39], s82 offen offset:192 sc1
    s_waitcnt vmcnt(0)
    v_cmp_eq_u64 s[76:77], v[130:131], v[8:9]
    v_cmp_eq_u64 s[78:79], v[134:135], v[8:9]
    s_nop 1
    s_and_b64 s[76:77], s[76:77], s[78:79]
    v_cmp_eq_u64 s[78:79], v[138:139], v[8:9]
    s_nop 1
    s_and_b64 s[76:77], s[76:77], s[78:79]
    v_cmp_eq_u64 s[78:79], v[142:143], v[8:9]
    s_nop 1
    s_and_b64 s[76:77], s[76:77], s[78:79]
    v_cmp_eq_u64 s[78:79], v[146:147], v[8:9]
    s_nop 1
    s_and_b64 s[76:77], s[76:77], s[78:79]
    v_cmp_eq_u64 s[78:79], v[150:151], v[8:9]
    s_nop 1
    s_and_b64 s[76:77], s[76:77], s[78:79]
    v_cmp_eq_u64 s[78:79], v[154:155], v[8:9]
    s_nop 1
    s_and_b64 s[76:77], s[76:77], s[78:79]
    v_cmp_eq_u64 s[78:79], v[158:159], v[8:9]
    s_nop 1
    s_and_b64 s[76:77], s[76:77], s[78:79]
    s_cmp_eq_u64 s[76:77], exec
    s_nop 0
    s_cbranch_scc1 L_h1_g0
    s_add_u32 s80, s80, 1
    s_cmp_lt_u32 s80, 400000
    s_cbranch_scc1 L_h1
L_h1_g0:
    v_mov_b32 v64, v128
    v_mov_b32 v65, v129
    v_mov_b32 v68, v132
    v_mov_b32 v69, v133
    v_mov_b32 v72, v136
    v_mov_b32 v73, v137
    v_mov_b32 v76, v140
    v_mov_b32 v77, v141
    v_mov_b32 v80, v144
    v_mov_b32 v81, v145
    v_mov_b32 v84, v148
    v_mov_b32 v85, v149
    v_mov_b32 v88, v152
    v_mov_b32 v89, v153
    v_mov_b32 v92, v156
    v_mov_b32 v93, v157
    s_nop 1
L_h1_got:
    v_max3_f32 v96, v80, v84, v88
    v_max_f32 v96, v96, v92
    v_mov_b32 v97, v96
    s_nop 1
    v_permlane32_swap_b32 v96, v97
    v_max_f32 v96, v96, v97
    v_sub_f32 v80, v80, v96
    v_sub_f32 v84, v84, v96
    v_sub_f32 v88, v88, v96
    v_sub_f32 v92, v92, v96
    v_exp_f32 v80, v80
    v_exp_f32 v84, v84
    v_exp_f32 v88, v88
    v_exp_f32 v92, v92
    v_mul_f32 v98, v80, v81
    v_mul_f32 v64, v80, v64
    v_mul_f32 v65, v80, v65
    v_fmac_f32 v98, v84, v85
    v_fmac_f32 v64, v84, v68
    v_fmac_f32 v65, v84, v69
    v_fmac_f32 v98, v88, v89
    v_fmac_f32 v64, v88, v72
    v_fmac_f32 v65, v88, v73
    v_fmac_f32 v98, v92, v93
    v_fmac_f32 v64, v92, v76
    v_fmac_f32 v65, v92, v77
    v_mov_b32 v99, v98
    v_mov_b32 v66, v64
    v_mov_b32 v67, v65
    v_permlane32_swap_b32 v98, v99
    v_permlane32_swap_b32 v64, v66
    v_permlane32_swap_b32 v65, v67
    v_add_f32 v98, v98, v99
    v_add_f32 v64, v64, v66
    v_add_f32 v65, v65, v67
    v_rcp_f32 v98, v98
    s_waitcnt lgkmcnt(0)
    v_mul_f32 v98, v40, v98
    v_mul_f32 v64, v98, v64
    v_mul_f32 v65, v98, v65
    v_cvt_pk_bf16_f32 v64, v64, v65
    ds_write_b32 v14, v64
    s_waitcnt lgkmcnt(0)
    s_barrier
    s_cmp_ge_u32 s91, 56
    s_cbranch_scc1 L_end
    s_mul_i32 s73, s54, 56
    s_add_u32 s73, s73, s91
    s_lshl_b32 s73, s73, 12
    s_add_u32 s73, s73, 1310720
    s_mov_b32 s48, s22
    s_mov_b32 s49, s23
    s_mov_b32 s50, 3584
    s_mul_i32 s74, s54, 896
    s_lshl_b32 s75, s91, 4
    s_add_u32 s74, s74, s75
    v_lshlrev_b32 v14, 2, v0
    s_mov_b32 s80, 0
    s_mov_b32 s80, 0
L_h2:
    buffer_load_dwordx4 v[128:131], v3, s[36:39], s73 offen offset:0 sc1
    buffer_load_dwordx4 v[132:135], v3, s[36:39], s73 offen offset:1024 sc1
    buffer_load_dwordx4 v[136:139], v3, s[36:39], s73 offen offset:2048 sc1
    buffer_load_dwordx4 v[140:143], v3, s[36:39], s73 offen offset:3072 sc1
    s_waitcnt vmcnt(0)
    v_cmp_eq_u64 s[76:77], v[130:131], v[8:9]
    v_cmp_eq_u64 s[78:79], v[134:135], v[8:9]
    s_nop 1
    s_and_b64 s[76:77], s[76:77], s[78:79]
    v_cmp_eq_u64 s[78:79], v[138:139], v[8:9]
    s_nop 1
    s_and_b64 s[76:77], s[76:77], s[78:79]
    v_cmp_eq_u64 s[78:79], v[142:143], v[8:9]
    s_nop 1
    s_and_b64 s[76:77], s[76:77], s[78:79]
    s_cmp_eq_u64 s[76:77], exec
    s_nop 0
    s_cbranch_scc1 L_h2_g0
    s_add_u32 s80, s80, 1
    s_cmp_lt_u32 s80, 400000
    s_cbranch_scc1 L_h2
L_h2_g0:
    v_mov_b32 v64, v128
    v_mov_b32 v65, v129
    v_mov_b32 v68, v132
    v_mov_b32 v69, v133
    v_mov_b32 v72, v136
    v_mov_b32 v73, v137
    v_mov_b32 v76, v140
    v_mov_b32 v77, v141
    s_nop 1
L_h2_got:
    v_add_f32 v64, v64, v68
    v_add_f32 v65, v65, v69
    v_add_f32 v72, v72, v76
    v_add_f32 v73, v73, v77
    v_add_f32 v64, v64, v72
    v_add_f32 v65, v65, v73
    s_nop 0
    v_add_f32_dpp v64, v64, v64 row_ror:4 row_mask:0xf bank_mask:0xf
    v_add_f32_dpp v65, v65, v65 row_ror:4 row_mask:0xf bank_mask:0xf
    s_nop 0
    v_add_f32_dpp v64, v64, v64 row_ror:8 row_mask:0xf bank_mask:0xf
    v_add_f32_dpp v65, v65, v65 row_ror:8 row_mask:0xf bank_mask:0xf
    v_mov_b32 v66, v64
    v_mov_b32 v67, v65
    s_nop 0
    v_permlane16_swap_b32 v64, v66
    v_permlane16_swap_b32 v65, v67
    v_add_f32 v64, v64, v66
    v_add_f32 v65, v65, v67
    v_mov_b32 v66, v64
    v_mov_b32 v67, v65
    s_nop 0
    v_permlane32_swap_b32 v64, v66
    v_permlane32_swap_b32 v65, v67
    v_add_f32 v64, v64, v66
    v_add_f32 v65, v65, v67
    v_cvt_pk_bf16_f32 v64, v64, v65
    s_mov_b64 exec, 15
    buffer_store_dword v64, v14, s[48:51], s74 offen
    s_cmp_lg_u32 s2, 0
    s_cbranch_scc1 L_end
    s_mov_b64 exec, 1
    buffer_store_dwordx2 v[8:9], v14, s[36:39], 0 offen sc1
L_end:
L_exit:
    s_endpgm
.section .rodata,"a"
.p2align 6
.amdhsa_kernel gated_mix__gqa_block_cached__dense_activation_relu__decode_kernel
  .amdhsa_next_free_vgpr 256
  .amdhsa_next_free_sgpr 102
  .amdhsa_accum_offset 256
  .amdhsa_group_segment_fixed_size 0
  .amdhsa_kernarg_size 96
  .amdhsa_user_sgpr_count 2
  .amdhsa_user_sgpr_kernarg_segment_ptr 1
  .amdhsa_system_sgpr_workgroup_id_x 1
.end_amdhsa_kernel
```
